```python
import torch

def _softmax(x, axis=-1):
    return torch.softmax(x, dim=axis)
def _gelu(x):
    return torch.nn.functional.gelu(x, approximate="tanh")
def _silu(x):
    return torch.nn.functional.silu(x)
def _sigmoid(x):
    return torch.sigmoid(x)
def _layernorm(x, axis=-1, eps=1e-5):
    m = x.mean(dim=axis, keepdim=True)
    v = x.var(dim=axis, keepdim=True, unbiased=False)
    return (x - m) / torch.sqrt(v + eps)
def _scatter_add(tgt, idx, src, axis=0):
    return tgt.clone().index_add_(axis, idx, src)
def _segment_sum(src, seg, n):
    out = torch.zeros((n,) + src.shape[1:], dtype=src.dtype)
    return out.index_add_(0, seg, src)
def _pad(x, pw):
    flat = tuple(v for pair in reversed(pw) for v in pair)
    return torch.nn.functional.pad(x, flat)

kernel_name = 'parallel_sum__linear_kernel_hedgehog__dense_activation_mish__prompt'

def setup_inputs():

    _w = (lambda a: (lambda t: t.to(torch.bfloat16) if t.is_floating_point() else t)(torch.as_tensor(a)))
    def _A_setup():
        B, S, D, H = 1, 2048, 448, 16
        Dh = D // H
        return {
            "x": _w((lambda *s: torch.randn(*s, dtype=torch.bfloat16) * 0.05)(B, S, D)),
            "wqkv": _w((lambda *s: torch.randn(*s, dtype=torch.bfloat16) * 0.2)(D, 3 * D)),
            "w_phi": _w((lambda *s: torch.randn(*s, dtype=torch.bfloat16) * 0.2)(H, Dh, Dh) * (Dh ** -0.5)),
            "wo": _w((lambda *s: torch.randn(*s, dtype=torch.bfloat16) * 0.05)(D, D)),
        }
    _A_in = _A_setup()

    def _B_setup():
        B, S, D, F = 1, 2048, 448, 1792
        return {
            "x": _w((lambda *s: torch.randn(*s, dtype=torch.bfloat16) * 0.05)(B, S, D)),
            "w1": _w((lambda *s: torch.randn(*s, dtype=torch.bfloat16) * 0.8)(D, F) * (D ** -0.5)),
            "b1": _w((lambda *s: torch.randn(*s, dtype=torch.bfloat16) * 0.4)(F)),
            "w2": _w((lambda *s: torch.randn(*s, dtype=torch.bfloat16) * 0.1)(F, D) * (F ** -0.5)),
        }
    _B_in = _B_setup()

    return {
        "A_x": _A_in["x"],
        "A_wqkv": _A_in["wqkv"],
        "A_w_phi": _A_in["w_phi"],
        "A_wo": _A_in["wo"],
        "B_x": _B_in["x"],
        "B_w1": _B_in["w1"],
        "B_b1": _B_in["b1"],
        "B_w2": _B_in["w2"],
    }

def reference(A_x, A_wqkv, A_w_phi, A_wo, B_x, B_w1, B_b1, B_w2):
    def _A_ref(x, wqkv, w_phi, wo):
        B, S, D = x.shape
        H = 16; Dh = D // H
        qkv = (lambda x, *d: x.permute(*d))((x @ wqkv).reshape(B, S, 3, H, Dh), 2, 0, 3, 1, 4)
        q, k, v = qkv[0], qkv[1], qkv[2]
        pq = torch.einsum("bhsd,hdf->bhsf", q, w_phi)
        pk = torch.einsum("bhsd,hdf->bhsf", k, w_phi)
        phi_q = torch.concatenate([_softmax(pq, axis=-1), _softmax(-pq, axis=-1)], axis=-1)
        phi_k = torch.concatenate([_softmax(pk, axis=-1), _softmax(-pk, axis=-1)], axis=-1)
        kv = torch.einsum("bhsf,bhsd->bhfd", phi_k, v)
        z  = torch.einsum("bhsf->bhf", phi_k)
        num = torch.einsum("bhqf,bhfd->bhqd", phi_q, kv)
        den = torch.einsum("bhqf,bhf->bhq", phi_q, z)[..., None] + 1e-6
        o = num / den
        return (lambda x, *d: x.permute(*d))(o, 0, 2, 1, 3).reshape(B, S, D) @ wo

    def _B_ref(x, w1, b1, w2):
        h = torch.einsum("bsd,df->bsf", x, w1) + b1
        sp = torch.log1p(torch.exp(-torch.abs(h))) + torch.where(h > 0, h, torch.zeros_like(h))
        act = h * torch.tanh(sp)
        return torch.einsum("bsf,fd->bsd", act, w2)

    x = A_x
    xn = _layernorm(x, axis=-1)
    return x + _A_ref(xn, A_wqkv, A_w_phi, A_wo) + _B_ref(xn, B_w1, B_b1, B_w2)
```

```asm
; @launch grid=(256,1,1) block=(512,1,1) lds=163840
.amdgcn_target "amdgcn-amd-amdhsa--gfx950"
.text
.globl parallel_sum__linear_kernel_hedgehog__dense_activation_mish__prompt_kernel
.p2align 8
.type parallel_sum__linear_kernel_hedgehog__dense_activation_mish__prompt_kernel,@function
parallel_sum__linear_kernel_hedgehog__dense_activation_mish__prompt_kernel:
    s_cmp_ge_u32 s2, 256
    s_nop 1
    s_cbranch_scc1 L_end
    s_load_dwordx2 s[8:9], s[0:1], 0
    s_load_dwordx2 s[40:41], s[0:1], 72
    s_cmp_lt_u32 s2, 128
    s_cbranch_scc1 L_attn
    s_load_dwordx2 s[12:13], s[0:1], 40
    s_load_dwordx2 s[16:17], s[0:1], 80
    s_load_dwordx2 s[32:33], s[0:1], 48
    s_load_dwordx2 s[24:25], s[0:1], 56
    s_load_dwordx2 s[28:29], s[0:1], 24
    s_load_dwordx2 s[20:21], s[0:1], 64
    v_lshrrev_b32 v48, 6, v0
    v_lshrrev_b32 v49, 3, v0
    v_and_b32 v50, 7, v0
    v_readfirstlane_b32 s48, v48
    v_lshl_add_u32 v51, v48, 3, v49
    v_bfe_u32 v52, v0, 4, 2
    v_mul_u32_u24 v51, 896, v51
    v_xor_b32 v52, v52, v50
    s_and_b32 s57, s2, 1
    s_lshl_b32 s57, s57, 3
    s_bfe_u32 s58, s2, 0x30003
    s_or_b32 s51, s57, s58
    s_mul_i32 s54, s51, 114688
    v_lshl_add_u32 v2, v52, 4, v51
    v_add_u32 v2, s54, v2
    v_xor_b32 v3, 64, v2
    v_add_u32 v3, 6144, v3
    s_and_b32 s52, s2, 6
    s_bfe_u32 s58, s2, 0x10006
    s_or_b32 s52, s52, s58
    s_mul_i32 s60, s52, 448
    s_and_b32 s58, s2, 64
    s_add_u32 s60, s60, s58
    s_lshr_b32 s50, s48, 2
    s_lshl_b32 s58, s50, 7
    s_add_u32 s58, s58, s60
    v_bfe_u32 v51, v0, 6, 2
    v_and_b32 v49, 7, v49
    v_lshl_add_u32 v51, v51, 4, v49
    v_mul_u32_u24 v51, 3584, v51
    v_lshrrev_b32 v52, 2, v0
    v_and_b32 v52, 4, v52
    v_xor_b32 v52, v52, v50
    v_lshl_add_u32 v4, v52, 4, v51
    v_add_u32 v4, s58, v4
    v_add_u32 v10, 27648, v4
    s_lshl_b32 s55, s48, 11
    s_mov_b32 s61, s60
    s_mov_b32 s82, 0x5316420
    s_mov_b32 s83, 0x64205316
    s_lshr_b32 s100, s2, 1
    s_and_b32 s100, s100, 0x3c
    s_lshr_b64 s[82:83], s[82:83], s100
    s_and_b32 s100, s82, 15
    s_lshl_b32 s100, s100, 7
    s_mul_i32 s56, s100, 1792
    s_mov_b32 s10, 1835008
    s_mov_b32 s11, 0x20000
    s_mov_b32 s14, 1605632
    s_mov_b32 s15, 0x20000
    v_and_b32 v1, 63, v0
    v_and_b32 v53, 31, v1
    v_lshrrev_b32 v54, 5, v1
    v_mul_u32_u24 v54, 896, v54
    v_lshlrev_b32 v11, 4, v53
    v_add_u32 v54, v11, v54
    v_mov_b32 v55, 2147483632
    v_cmp_gt_u32 vcc, 28, v53
    s_lshl_b32 s44, s52, 3
    s_add_u32 s44, s44, s48
    v_cndmask_b32 v54, v55, v54, vcc
    s_mul_i32 s44, s44, 1792
    s_add_u32 s44, s44, s54
    s_mov_b32 s42, 256
    s_mov_b32 s43, 0x20000
    s_waitcnt lgkmcnt(0)
    s_add_u32 m0, s55, 0
    s_nop 0
    buffer_load_dwordx4 v2, s[8:11], s100 offen lds
    buffer_load_dwordx4 v3, s[8:11], s100 offen offset:1024 lds
    s_add_u32 m0, s55, 98304
    s_nop 0
    buffer_load_dwordx4 v4, s[12:15], s56 offen lds
    buffer_load_dwordx4 v10, s[12:15], s56 offen offset:1024 lds
    s_add_u32 s57, s100, 128
    s_sub_u32 s100, s100, 768
    s_min_u32 s100, s100, s57
    s_mul_i32 s56, s100, 1792
    buffer_load_dwordx4 v[96:99], v54, s[8:11], s44 offen
    buffer_load_dwordx4 v[100:103], v54, s[8:11], s44 offen offset:448
    s_mov_b32 s18, 268435456
    s_mov_b32 s19, 0x20000
    s_mov_b32 s34, 3584
    s_mov_b32 s35, 0x20000
    s_mov_b32 s26, 1605632
    s_mov_b32 s27, 0x20000
    s_mov_b32 s30, 401408
    s_mov_b32 s31, 0x20000
    s_mov_b32 s22, 1835008
    s_mov_b32 s23, 0x20000
    s_mov_b32 s42, 256
    s_mov_b32 s43, 0x20000
    s_and_b32 s49, s48, 3
    s_lshl_b32 s57, s50, 1
    s_add_u32 s57, s57, s49
    s_and_b32 s53, s57, 3
    s_mov_b32 s68, -1
    s_mov_b32 s69, 0
    s_mov_b32 s75, 0x3f3504f3
    v_lshlrev_b32 v5, 4, v1
    v_and_b32 v48, 31, v1
    v_lshrrev_b32 v49, 5, v1
    s_lshl_b32 s57, s49, 5
    v_add_u32 v50, s57, v48
    v_lshlrev_b32 v0, 1, v48
    v_lshrrev_b32 v51, 1, v50
    v_and_b32 v51, 7, v51
    v_lshlrev_b32 v50, 7, v50
    s_lshl_b32 s57, s50, 7
    s_and_b32 s58, s52, s50
    s_lshl_b32 s58, s58, 9
    s_add_u32 s61, s61, s57
    s_add_u32 s62, s61, 64
    s_add_u32 s63, s61, 256
    s_sub_u32 s63, s63, s58
    s_lshr_b32 s58, s58, 3
    s_add_u32 s63, s63, s58
    s_add_u32 s64, s63, 64
    s_add_u32 s57, s53, 0
    s_and_b32 s57, s57, 3
    s_lshl_b32 s58, s57, 1
    v_add_u32 v52, s58, v49
    v_xor_b32 v52, v52, v51
    v_lshl_add_u32 v12, v52, 4, v50
    s_add_u32 s57, s53, 1
    s_and_b32 s57, s57, 3
    s_lshl_b32 s58, s57, 1
    v_add_u32 v52, s58, v49
    v_xor_b32 v52, v52, v51
    v_lshl_add_u32 v13, v52, 4, v50
    s_add_u32 s57, s53, 2
    s_and_b32 s57, s57, 3
    s_lshl_b32 s58, s57, 1
    v_add_u32 v52, s58, v49
    v_xor_b32 v52, v52, v51
    v_lshl_add_u32 v14, v52, 4, v50
    s_add_u32 s57, s53, 3
    s_and_b32 s57, s57, 3
    s_lshl_b32 s58, s57, 1
    v_add_u32 v52, s58, v49
    v_xor_b32 v52, v52, v51
    v_lshl_add_u32 v15, v52, 4, v50
    v_lshrrev_b32 v48, 5, v1
    v_lshlrev_b32 v48, 3, v48
    v_bfe_u32 v49, v1, 2, 2
    v_add_u32 v48, v48, v49
    v_lshlrev_b32 v48, 7, v48
    v_bfe_u32 v49, v1, 4, 1
    v_lshlrev_b32 v49, 5, v49
    v_and_b32 v50, 3, v1
    v_lshl_add_u32 v49, v50, 3, v49
    v_bfe_u32 v50, v1, 3, 1
    v_lshlrev_b32 v50, 6, v50
    v_xor_b32 v49, v49, v50
    v_add_u32 v48, v48, v49
    s_lshl_b32 s60, s50, 13
    s_add_u32 s60, s60, 65536
    v_add_u32 v48, s60, v48
    s_add_u32 s57, s53, 0
    s_and_b32 s57, s57, 3
    s_lshl_b32 s57, s57, 11
    v_add_u32 v16, s57, v48
    v_xor_b32 v20, 64, v16
    s_add_u32 s57, s53, 1
    s_and_b32 s57, s57, 3
    s_lshl_b32 s57, s57, 11
    v_add_u32 v17, s57, v48
    v_xor_b32 v21, 64, v17
    s_add_u32 s57, s53, 2
    s_and_b32 s57, s57, 3
    s_lshl_b32 s57, s57, 11
    v_add_u32 v18, s57, v48
    v_xor_b32 v22, 64, v18
    s_add_u32 s57, s53, 3
    s_and_b32 s57, s57, 3
    s_lshl_b32 s57, s57, 11
    v_add_u32 v19, s57, v48
    v_xor_b32 v23, 64, v19
    s_mov_b32 s82, 0x00020001
    s_mov_b32 s83, 0x00020001
    v_mov_b32 v25, 0x3f803f80
    v_cndmask_b32 v24, 0, v25, s[82:83]
    v_mov_b32 v25, v24
    v_mov_b32 v26, v24
    v_mov_b32 v27, v24
    s_lshl_b32 s70, s51, 2
    s_add_u32 s70, s70, s49
    s_lshl_b32 s101, s70, 8
    s_mul_i32 s70, s70, 147456
    s_lshl_b32 s71, s61, 5
    s_add_u32 s71, s71, s70
    s_lshl_b32 s72, s62, 5
    s_add_u32 s72, s72, s70
    s_lshl_b32 s73, s63, 5
    s_add_u32 s73, s73, s70
    s_lshl_b32 s74, s64, 5
    s_add_u32 s74, s74, s70
    s_lshl_b32 s58, s52, 1
    s_add_u32 s58, s58, s50
    s_lshl_b32 s58, s58, 3
    s_add_u32 s101, s101, s58
    s_add_u32 s101, s101, 12582912
    s_lshl_b32 s57, s50, 10
    s_lshl_b32 s58, s49, 7
    s_add_u32 s57, s57, s58
    s_add_u32 s57, s57, 49152
    v_and_b32 v43, 1, v1
    v_lshlrev_b32 v43, 6, v43
    v_lshrrev_b32 v48, 4, v1
    v_lshl_add_u32 v43, v48, 4, v43
    v_add_u32 v43, s57, v43
    s_lshl_b32 s57, s51, 3
    s_add_u32 s57, s57, s52
    s_lshl_b32 s57, s57, 3
    s_add_u32 s57, s57, s48
    s_lshl_b32 s57, s57, 5
    s_add_u32 s46, s57, 11534336
    s_lshl_b32 s57, s51, 2
    s_add_u32 s57, s57, s49
    s_lshl_b32 s57, s57, 9
    s_add_u32 s45, s57, 11534336
    s_lshr_b32 s60, s2, 3
    s_sub_u32 s60, s60, 16
    s_mul_i32 s57, s60, 9363
    s_lshr_b32 s57, s57, 16
    s_mul_i32 s58, s57, 7
    s_sub_u32 s81, s60, s58
    s_and_b32 s58, s2, 7
    s_lshl2_add_u32 s80, s58, s57
    s_and_b32 s57, s48, 3
    s_lshr_b32 s58, s48, 2
    s_lshl_b32 s59, s81, 7
    s_mul_i32 s3, s57, 401408
    s_mul_i32 s76, s58, 28672
    s_add_u32 s3, s3, s76
    s_add_u32 s3, s3, s59
    s_mul_i32 s4, s57, 100352
    s_mul_i32 s76, s58, 25088
    s_add_u32 s4, s4, s76
    s_add_u32 s4, s4, s59
    s_lshl_b32 s77, s80, 1
    s_add_u32 s77, s77, s58
    s_mul_i32 s7, s77, 28672
    s_add_u32 s7, s7, s59
    s_lshl_b32 s76, s57, 5
    s_add_u32 s7, s7, s76
    s_mul_i32 s6, s77, 147456
    s_mul_i32 s76, s57, 28672
    s_add_u32 s5, s6, s76
    s_lshl_b32 s76, s57, 13
    s_add_u32 s6, s6, s76
    s_add_u32 s6, s6, 114688
    s_lshl_b32 s77, s77, 8
    s_lshl_b32 s59, s57, 5
    s_add_u32 s77, s77, s59
    s_add_u32 s77, s77, 12582912
    s_lshl_b32 s58, s58, 12
    s_add_u32 s76, s76, s58
    v_lshrrev_b32 v52, 3, v1
    v_bfe_u32 v53, v1, 4, 1
    v_lshlrev_b32 v53, 2, v53
    v_and_b32 v126, 7, v1
    v_xor_b32 v53, v126, v53
    v_lshlrev_b32 v53, 4, v53
    v_mul_u32_u24 v126, 896, v52
    v_add_u32 v126, v126, v53
    v_add_u32 v127, 5, v52
    v_lshrrev_b32 v127, 3, v127
    v_sub_u32 v127, v52, v127
    v_add_u32 v52, 1, v52
    v_lshrrev_b32 v52, 3, v52
    v_sub_u32 v127, v127, v52
    v_mul_u32_u24 v127, 896, v127
    v_add_u32 v127, v127, v53
    v_and_b32 v9, 3, v1
    v_lshlrev_b32 v9, 3, v9
    s_add_u32 m0, s55, 16384
    s_nop 0
    buffer_load_dwordx4 v2, s[8:11], s100 offen lds
    buffer_load_dwordx4 v3, s[8:11], s100 offen offset:1024 lds
    s_add_u32 m0, s55, 114688
    s_nop 0
    buffer_load_dwordx4 v4, s[12:15], s56 offen lds
    buffer_load_dwordx4 v10, s[12:15], s56 offen offset:1024 lds
    s_add_u32 s57, s100, 128
    s_sub_u32 s100, s100, 768
    s_min_u32 s100, s100, s57
    s_mul_i32 s56, s100, 1792
    s_waitcnt vmcnt(6)
    s_barrier
    ds_read_b128 v[128:131], v12 offset:0
    ds_read_b64_tr_b16 v[56:57], v16 offset:32768
    ds_read_b64_tr_b16 v[58:59], v16 offset:33280
    ds_read_b64_tr_b16 v[60:61], v20 offset:32768
    ds_read_b64_tr_b16 v[62:63], v20 offset:33280
    ds_read_b128 v[132:135], v13 offset:0
    ds_read_b128 v[136:139], v14 offset:0
    ds_read_b64_tr_b16 v[240:241], v17 offset:32768
    ds_read_b64_tr_b16 v[242:243], v17 offset:33280
    ds_read_b64_tr_b16 v[244:245], v21 offset:32768
    ds_read_b64_tr_b16 v[246:247], v21 offset:33280
    ds_read_b128 v[140:143], v15 offset:0
    s_waitcnt lgkmcnt(7)
    v_mfma_f32_32x32x16_bf16 v[64:79], v[56:59], v[128:131], 0
    s_add_u32 m0, s55, 32768
    v_mfma_f32_16x16x32_bf16 v[28:31], v[56:59], v[24:27], 0
    ds_read_b64_tr_b16 v[248:249], v18 offset:32768
    ds_read_b64_tr_b16 v[250:251], v18 offset:33280
    buffer_load_dwordx4 v2, s[8:11], s100 offen lds
    v_mfma_f32_32x32x16_bf16 v[80:95], v[60:63], v[128:131], 0
    v_mfma_f32_16x16x32_bf16 v[32:35], v[60:63], v[24:27], 0
    ds_read_b64_tr_b16 v[252:253], v22 offset:32768
    ds_read_b64_tr_b16 v[254:255], v22 offset:33280
    buffer_load_dwordx4 v3, s[8:11], s100 offen offset:1024 lds
    s_waitcnt vmcnt(7)
    v_lshlrev_b32 v104, 16, v96
    v_and_b32 v105, 0xffff0000, v96
    v_lshlrev_b32 v106, 16, v97
    v_and_b32 v107, 0xffff0000, v97
    s_waitcnt lgkmcnt(5)
    v_mfma_f32_32x32x16_bf16 v[64:79], v[240:243], v[132:135], v[64:79]
    s_add_u32 m0, s55, 65536
    ds_read_b64_tr_b16 v[56:57], v19 offset:32768
    ds_read_b64_tr_b16 v[58:59], v19 offset:33280
    buffer_load_dwordx4 v4, s[12:15], s56 offen lds
    v_lshlrev_b32 v108, 16, v98
    v_and_b32 v109, 0xffff0000, v98
    v_lshlrev_b32 v110, 16, v99
    v_and_b32 v111, 0xffff0000, v99
    v_mfma_f32_32x32x16_bf16 v[80:95], v[244:247], v[132:135], v[80:95]
    ds_read_b64_tr_b16 v[60:61], v23 offset:32768
    ds_read_b64_tr_b16 v[62:63], v23 offset:33280
    s_waitcnt vmcnt(3)
    s_barrier
    buffer_load_dwordx4 v10, s[12:15], s56 offen offset:1024 lds
    s_add_u32 s57, s100, 128
    s_sub_u32 s100, s100, 768
    s_min_u32 s100, s100, s57
    s_mul_i32 s56, s100, 1792
    v_lshlrev_b32 v112, 16, v100
    v_and_b32 v113, 0xffff0000, v100
    v_lshlrev_b32 v114, 16, v101
    v_and_b32 v115, 0xffff0000, v101
    s_waitcnt lgkmcnt(4)
    v_mfma_f32_32x32x16_bf16 v[64:79], v[248:251], v[136:139], v[64:79]
    s_add_u32 m0, s55, 49152
    ds_read_b128 v[144:147], v12 offset:16384
    ds_read_b64_tr_b16 v[240:241], v16 offset:49152
    ds_read_b64_tr_b16 v[242:243], v16 offset:49664
    buffer_load_dwordx4 v2, s[8:11], s100 offen lds
    buffer_load_dwordx2 v[6:7], off, s[40:43], 0 sc1
    v_lshlrev_b32 v116, 16, v102
    v_and_b32 v117, 0xffff0000, v102
    v_lshlrev_b32 v118, 16, v103
    v_and_b32 v119, 0xffff0000, v103
    v_mfma_f32_32x32x16_bf16 v[80:95], v[252:255], v[136:139], v[80:95]
    ds_read_b64_tr_b16 v[244:245], v20 offset:49152
    ds_read_b64_tr_b16 v[246:247], v20 offset:49664
    ds_read_b128 v[148:151], v13 offset:16384
    v_add_f32 v96, v104, v105
    v_add_f32 v97, v106, v107
    v_add_f32 v98, v108, v109
    v_add_f32 v99, v110, v111
    s_waitcnt lgkmcnt(6)
    v_mfma_f32_32x32x16_bf16 v[64:79], v[56:59], v[140:143], v[64:79]
    ds_read_b128 v[152:155], v14 offset:16384
    ds_read_b64_tr_b16 v[248:249], v17 offset:49152
    ds_read_b64_tr_b16 v[250:251], v17 offset:49664
    buffer_load_dwordx4 v3, s[8:11], s100 offen offset:1024 lds
    v_add_f32 v100, v112, v113
    v_add_f32 v101, v114, v115
    v_add_f32 v102, v116, v117
    v_add_f32 v103, v118, v119
    v_mfma_f32_32x32x16_bf16 v[80:95], v[60:63], v[140:143], v[80:95]
    ds_read_b64_tr_b16 v[252:253], v21 offset:49152
    ds_read_b64_tr_b16 v[254:255], v21 offset:49664
    ds_read_b128 v[156:159], v15 offset:16384
    v_add_f32 v96, v96, v100
    v_add_f32 v97, v97, v101
    v_add_f32 v98, v98, v102
    v_add_f32 v99, v99, v103
    s_waitcnt lgkmcnt(7)
    v_mfma_f32_32x32x16_bf16 v[64:79], v[240:243], v[144:147], v[64:79]
    s_add_u32 m0, s55, 81920
    v_mfma_f32_16x16x32_bf16 v[28:31], v[240:243], v[24:27], v[28:31]
    ds_read_b64_tr_b16 v[56:57], v18 offset:49152
    ds_read_b64_tr_b16 v[58:59], v18 offset:49664
    buffer_load_dwordx4 v4, s[12:15], s56 offen lds
    v_add_f32 v96, v96, v97
    v_add_f32 v98, v98, v99
    v_and_b32 v125, 31, v1
    v_add_f32 v120, v96, v98
    v_mfma_f32_32x32x16_bf16 v[80:95], v[244:247], v[144:147], v[80:95]
    v_mfma_f32_16x16x32_bf16 v[32:35], v[244:247], v[24:27], v[32:35]
    ds_read_b64_tr_b16 v[60:61], v22 offset:49152
    ds_read_b64_tr_b16 v[62:63], v22 offset:49664
    v_cmp_gt_u32 s[36:37], 28, v125
    v_add_f32_dpp v120, v120, v120 quad_perm:[1,0,3,2] row_mask:0xf bank_mask:0xf
    s_nop 1
    v_add_f32_dpp v120, v120, v120 quad_perm:[2,3,0,1] row_mask:0xf bank_mask:0xf
    s_nop 1
    v_add_f32_dpp v120, v120, v120 row_half_mirror row_mask:0xf bank_mask:0xf
    s_waitcnt lgkmcnt(5)
    v_mfma_f32_32x32x16_bf16 v[64:79], v[248:251], v[148:151], v[64:79]
    ds_read_b64_tr_b16 v[240:241], v19 offset:49152
    ds_read_b64_tr_b16 v[242:243], v19 offset:49664
    buffer_load_dwordx4 v10, s[12:15], s56 offen offset:1024 lds
    s_add_u32 s57, s100, 128
    s_sub_u32 s100, s100, 768
    s_min_u32 s100, s100, s57
    s_mul_i32 s56, s100, 1792
    v_add_f32_dpp v120, v120, v120 row_mirror row_mask:0xf bank_mask:0xf
    v_mov_b32 v124, v120
    s_nop 1
    v_permlane16_swap_b32 v120, v124
    v_add_f32 v120, v120, v124
    v_mfma_f32_32x32x16_bf16 v[80:95], v[252:255], v[148:151], v[80:95]
    ds_read_b64_tr_b16 v[244:245], v23 offset:49152
    ds_read_b64_tr_b16 v[246:247], v23 offset:49664
    s_waitcnt vmcnt(5)
    s_barrier
    v_mul_f32 v120, 0xbb124925, v120
    v_add_f32 v104, v104, v120
    v_add_f32 v105, v105, v120
    v_add_f32 v106, v106, v120
    s_waitcnt lgkmcnt(4)
    v_mfma_f32_32x32x16_bf16 v[64:79], v[56:59], v[152:155], v[64:79]
    s_add_u32 m0, s55, 0
    ds_read_b128 v[160:163], v12 offset:32768
    ds_read_b64_tr_b16 v[248:249], v16 offset:0
    ds_read_b64_tr_b16 v[250:251], v16 offset:512
    buffer_load_dwordx4 v2, s[8:11], s100 offen lds
    v_add_f32 v107, v107, v120
    v_add_f32 v108, v108, v120
    v_add_f32 v109, v109, v120
    v_add_f32 v110, v110, v120
    v_mfma_f32_32x32x16_bf16 v[80:95], v[60:63], v[152:155], v[80:95]
    ds_read_b64_tr_b16 v[252:253], v20 offset:0
    ds_read_b64_tr_b16 v[254:255], v20 offset:512
    ds_read_b128 v[164:167], v13 offset:32768
    v_add_f32 v111, v111, v120
    v_add_f32 v112, v112, v120
    v_add_f32 v113, v113, v120
    v_add_f32 v114, v114, v120
    s_waitcnt lgkmcnt(6)
    v_mfma_f32_32x32x16_bf16 v[64:79], v[240:243], v[156:159], v[64:79]
    ds_read_b128 v[168:171], v14 offset:32768
    ds_read_b64_tr_b16 v[56:57], v17 offset:0
    ds_read_b64_tr_b16 v[58:59], v17 offset:512
    buffer_load_dwordx4 v3, s[8:11], s100 offen offset:1024 lds
    v_add_f32 v115, v115, v120
    v_add_f32 v116, v116, v120
    v_add_f32 v117, v117, v120
    v_add_f32 v118, v118, v120
    v_mfma_f32_32x32x16_bf16 v[80:95], v[244:247], v[156:159], v[80:95]
    ds_read_b64_tr_b16 v[60:61], v21 offset:0
    ds_read_b64_tr_b16 v[62:63], v21 offset:512
    ds_read_b128 v[172:175], v15 offset:32768
    v_add_f32 v119, v119, v120
    v_mul_f32 v96, v104, v104
    v_mul_f32 v97, v105, v105
    v_mul_f32 v98, v106, v106
    s_waitcnt lgkmcnt(7)
    v_mfma_f32_32x32x16_bf16 v[64:79], v[248:251], v[160:163], v[64:79]
    s_add_u32 m0, s55, 98304
    v_mfma_f32_16x16x32_bf16 v[28:31], v[248:251], v[24:27], v[28:31]
    ds_read_b64_tr_b16 v[240:241], v18 offset:0
    ds_read_b64_tr_b16 v[242:243], v18 offset:512
    buffer_load_dwordx4 v4, s[12:15], s56 offen lds
    v_mul_f32 v99, v107, v107
    v_fmac_f32 v96, v108, v108
    v_fmac_f32 v97, v109, v109
    v_fmac_f32 v98, v110, v110
    v_mfma_f32_32x32x16_bf16 v[80:95], v[252:255], v[160:163], v[80:95]
    v_mfma_f32_16x16x32_bf16 v[32:35], v[252:255], v[24:27], v[32:35]
    ds_read_b64_tr_b16 v[244:245], v22 offset:0
    ds_read_b64_tr_b16 v[246:247], v22 offset:512
    v_fmac_f32 v99, v111, v111
    v_fmac_f32 v96, v112, v112
    v_fmac_f32 v97, v113, v113
    v_fmac_f32 v98, v114, v114
    s_waitcnt lgkmcnt(5)
    v_mfma_f32_32x32x16_bf16 v[64:79], v[56:59], v[164:167], v[64:79]
    ds_read_b64_tr_b16 v[248:249], v19 offset:0
    ds_read_b64_tr_b16 v[250:251], v19 offset:512
    buffer_load_dwordx4 v10, s[12:15], s56 offen offset:1024 lds
    s_add_u32 s57, s100, 128
    s_sub_u32 s100, s100, 768
    s_min_u32 s100, s100, s57
    s_mul_i32 s56, s100, 1792
    v_fmac_f32 v99, v115, v115
    v_fmac_f32 v96, v116, v116
    v_fmac_f32 v97, v117, v117
    v_fmac_f32 v98, v118, v118
    v_mfma_f32_32x32x16_bf16 v[80:95], v[60:63], v[164:167], v[80:95]
    ds_read_b64_tr_b16 v[252:253], v23 offset:0
    ds_read_b64_tr_b16 v[254:255], v23 offset:512
    s_waitcnt vmcnt(4)
    s_barrier
    v_fmac_f32 v99, v119, v119
    v_add_f32 v96, v96, v97
    v_add_f32 v98, v98, v99
    v_add_f32 v122, v96, v98
    s_waitcnt lgkmcnt(4)
    v_mfma_f32_32x32x16_bf16 v[64:79], v[240:243], v[168:171], v[64:79]
    s_add_u32 m0, s55, 16384
    ds_read_b128 v[176:179], v12 offset:49152
    ds_read_b64_tr_b16 v[56:57], v16 offset:16384
    ds_read_b64_tr_b16 v[58:59], v16 offset:16896
    buffer_load_dwordx4 v2, s[8:11], s100 offen lds
    v_cndmask_b32 v122, 0, v122, s[36:37]
    s_nop 1
    v_add_f32_dpp v122, v122, v122 quad_perm:[1,0,3,2] row_mask:0xf bank_mask:0xf
    s_nop 1
    v_add_f32_dpp v122, v122, v122 quad_perm:[2,3,0,1] row_mask:0xf bank_mask:0xf
    s_nop 1
    v_add_f32_dpp v122, v122, v122 row_half_mirror row_mask:0xf bank_mask:0xf
    v_mfma_f32_32x32x16_bf16 v[80:95], v[244:247], v[168:171], v[80:95]
    ds_read_b64_tr_b16 v[60:61], v20 offset:16384
    ds_read_b64_tr_b16 v[62:63], v20 offset:16896
    ds_read_b128 v[180:183], v13 offset:49152
    v_add_f32_dpp v122, v122, v122 row_mirror row_mask:0xf bank_mask:0xf
    v_mov_b32 v124, v122
    s_nop 1
    v_permlane16_swap_b32 v122, v124
    v_add_f32 v122, v122, v124
    s_waitcnt lgkmcnt(6)
    v_mfma_f32_32x32x16_bf16 v[64:79], v[248:251], v[172:175], v[64:79]
    ds_read_b128 v[184:187], v14 offset:49152
    ds_read_b64_tr_b16 v[240:241], v17 offset:16384
    ds_read_b64_tr_b16 v[242:243], v17 offset:16896
    buffer_load_dwordx4 v3, s[8:11], s100 offen offset:1024 lds
    v_mul_f32 v122, 0x3b124925, v122
    v_lshrrev_b32 v124, 1, v1
    v_add_f32 v122, 0x3727c5ac, v122
    v_cmp_eq_u32 s[36:37], 0, v125
    v_mfma_f32_32x32x16_bf16 v[80:95], v[252:255], v[172:175], v[80:95]
    ds_read_b64_tr_b16 v[244:245], v21 offset:16384
    ds_read_b64_tr_b16 v[246:247], v21 offset:16896
    ds_read_b128 v[188:191], v15 offset:49152
    v_rsq_f32 v121, v122
    v_sqrt_f32 v122, v122
    v_mov_b32 v125, 2147483632
    v_cndmask_b32 v125, v125, v124, s[36:37]
    s_waitcnt lgkmcnt(7)
    v_mfma_f32_32x32x16_bf16 v[64:79], v[56:59], v[176:179], v[64:79]
    s_add_u32 m0, s55, 114688
    v_mfma_f32_16x16x32_bf16 v[28:31], v[56:59], v[24:27], v[28:31]
    ds_read_b64_tr_b16 v[248:249], v18 offset:16384
    ds_read_b64_tr_b16 v[250:251], v18 offset:16896
    buffer_load_dwordx4 v4, s[12:15], s56 offen lds
    v_readfirstlane_b32 s66, v6
    s_cmp_eq_u32 s66, 0
    s_cbranch_scc1 L_ns_1
L_nb_2:
    v_and_b32 v48, 2, v1
    v_cmp_ne_u32 vcc, 0, v48
    v_and_b32 v48, 1, v1
    v_lshlrev_b32 v48, 4, v48
    v_cndmask_b32 v49, v6, v7, vcc
    v_lshrrev_b32 v49, v48, v49
    v_lshlrev_b32 v8, 16, v49
    v_mfma_f32_32x32x16_bf16 v[80:95], v[60:63], v[176:179], v[80:95]
    v_mfma_f32_16x16x32_bf16 v[32:35], v[60:63], v[24:27], v[32:35]
    ds_read_b64_tr_b16 v[252:253], v22 offset:16384
    ds_read_b64_tr_b16 v[254:255], v22 offset:16896
    v_mov_b32 v123, v6
    buffer_store_dwordx4 v[120:123], v125, s[16:19], s46 offen sc1
    s_waitcnt lgkmcnt(5)
    v_mfma_f32_32x32x16_bf16 v[64:79], v[240:243], v[180:183], v[64:79]
    ds_read_b64_tr_b16 v[56:57], v19 offset:16384
    ds_read_b64_tr_b16 v[58:59], v19 offset:16896
    buffer_load_dwordx4 v10, s[12:15], s56 offen offset:1024 lds
    s_add_u32 s57, s100, 128
    s_sub_u32 s100, s100, 768
    s_min_u32 s100, s100, s57
    s_mul_i32 s56, s100, 1792
    v_mfma_f32_32x32x16_bf16 v[80:95], v[244:247], v[180:183], v[80:95]
    ds_read_b64_tr_b16 v[60:61], v23 offset:16384
    ds_read_b64_tr_b16 v[62:63], v23 offset:16896
    s_waitcnt vmcnt(5)
    s_barrier
    buffer_load_ushort v40, v0, s[32:35], s61 offen
    buffer_load_ushort v41, v0, s[32:35], s62 offen
    s_waitcnt lgkmcnt(4)
    v_mfma_f32_32x32x16_bf16 v[64:79], v[248:251], v[184:187], v[64:79]
    s_add_u32 m0, s55, 32768
    ds_read_b128 v[192:195], v12 offset:0
    ds_read_b64_tr_b16 v[240:241], v16 offset:32768
    ds_read_b64_tr_b16 v[242:243], v16 offset:33280
    buffer_load_dwordx4 v2, s[8:11], s100 offen lds
    v_mfma_f32_32x32x16_bf16 v[80:95], v[252:255], v[184:187], v[80:95]
    ds_read_b64_tr_b16 v[244:245], v20 offset:32768
    ds_read_b64_tr_b16 v[246:247], v20 offset:33280
    ds_read_b128 v[196:199], v13 offset:0
    s_waitcnt lgkmcnt(6)
    v_mfma_f32_32x32x16_bf16 v[64:79], v[56:59], v[188:191], v[64:79]
    ds_read_b128 v[200:203], v14 offset:0
    ds_read_b64_tr_b16 v[248:249], v17 offset:32768
    ds_read_b64_tr_b16 v[250:251], v17 offset:33280
    buffer_load_dwordx4 v3, s[8:11], s100 offen offset:1024 lds
    v_mfma_f32_32x32x16_bf16 v[80:95], v[60:63], v[188:191], v[80:95]
    ds_read_b64_tr_b16 v[252:253], v21 offset:32768
    ds_read_b64_tr_b16 v[254:255], v21 offset:33280
    ds_read_b128 v[204:207], v15 offset:0
    s_waitcnt lgkmcnt(7)
    v_mfma_f32_32x32x16_bf16 v[64:79], v[240:243], v[192:195], v[64:79]
    s_add_u32 m0, s55, 65536
    v_mfma_f32_16x16x32_bf16 v[28:31], v[240:243], v[24:27], v[28:31]
    ds_read_b64_tr_b16 v[56:57], v18 offset:32768
    ds_read_b64_tr_b16 v[58:59], v18 offset:33280
    buffer_load_dwordx4 v4, s[12:15], s56 offen lds
    v_mfma_f32_32x32x16_bf16 v[80:95], v[244:247], v[192:195], v[80:95]
    v_mfma_f32_16x16x32_bf16 v[32:35], v[244:247], v[24:27], v[32:35]
    ds_read_b64_tr_b16 v[60:61], v22 offset:32768
    ds_read_b64_tr_b16 v[62:63], v22 offset:33280
    s_waitcnt lgkmcnt(5)
    v_mfma_f32_32x32x16_bf16 v[64:79], v[248:251], v[196:199], v[64:79]
    ds_read_b64_tr_b16 v[240:241], v19 offset:32768
    ds_read_b64_tr_b16 v[242:243], v19 offset:33280
    buffer_load_dwordx4 v10, s[12:15], s56 offen offset:1024 lds
    s_add_u32 s57, s100, 128
    s_sub_u32 s100, s100, 768
    s_min_u32 s100, s100, s57
    s_mul_i32 s56, s100, 1792
    v_mfma_f32_32x32x16_bf16 v[80:95], v[252:255], v[196:199], v[80:95]
    ds_read_b64_tr_b16 v[244:245], v23 offset:32768
    ds_read_b64_tr_b16 v[246:247], v23 offset:33280
    s_waitcnt vmcnt(6)
    s_barrier
    s_waitcnt lgkmcnt(4)
    v_mfma_f32_32x32x16_bf16 v[64:79], v[56:59], v[200:203], v[64:79]
    s_add_u32 m0, s55, 81920
    ds_read_b128 v[208:211], v12 offset:16384
    ds_read_b64_tr_b16 v[248:249], v16 offset:49152
    ds_read_b64_tr_b16 v[250:251], v16 offset:49664
    s_and_b32 s57, s52, s50
    s_lshl_b32 s57, s57, 9
    s_sub_u32 s57, 256, s57
    v_add_u32 v4, s57, v4
    v_add_u32 v10, s57, v10
    buffer_load_dwordx4 v4, s[12:15], s56 offen lds
    v_mfma_f32_32x32x16_bf16 v[80:95], v[60:63], v[200:203], v[80:95]
    ds_read_b64_tr_b16 v[252:253], v20 offset:49152
    ds_read_b64_tr_b16 v[254:255], v20 offset:49664
    ds_read_b128 v[212:215], v13 offset:16384
    v_mov_b32 v2, v126
    v_mov_b32 v3, v127
    s_waitcnt lgkmcnt(6)
    v_mfma_f32_32x32x16_bf16 v[64:79], v[240:243], v[204:207], v[64:79]
    ds_read_b128 v[216:219], v14 offset:16384
    ds_read_b64_tr_b16 v[56:57], v17 offset:49152
    ds_read_b64_tr_b16 v[58:59], v17 offset:49664
    buffer_load_dwordx4 v10, s[12:15], s56 offen offset:1024 lds
    s_add_u32 s57, s100, 128
    s_sub_u32 s100, s100, 768
    s_min_u32 s100, s100, s57
    s_mul_i32 s56, s100, 1792
    v_mfma_f32_32x32x16_bf16 v[80:95], v[244:247], v[204:207], v[80:95]
    ds_read_b64_tr_b16 v[60:61], v21 offset:49152
    ds_read_b64_tr_b16 v[62:63], v21 offset:49664
    ds_read_b128 v[220:223], v15 offset:16384
    s_waitcnt lgkmcnt(7)
    v_mfma_f32_32x32x16_bf16 v[64:79], v[248:251], v[208:211], v[64:79]
    v_mfma_f32_16x16x32_bf16 v[28:31], v[248:251], v[24:27], v[28:31]
    ds_read_b64_tr_b16 v[240:241], v18 offset:49152
    ds_read_b64_tr_b16 v[242:243], v18 offset:49664
    v_mfma_f32_32x32x16_bf16 v[80:95], v[252:255], v[208:211], v[80:95]
    v_mfma_f32_16x16x32_bf16 v[32:35], v[252:255], v[24:27], v[32:35]
    ds_read_b64_tr_b16 v[244:245], v22 offset:49152
    ds_read_b64_tr_b16 v[246:247], v22 offset:49664
    s_waitcnt lgkmcnt(5)
    v_mfma_f32_32x32x16_bf16 v[64:79], v[56:59], v[212:215], v[64:79]
    ds_read_b64_tr_b16 v[248:249], v19 offset:49152
    ds_read_b64_tr_b16 v[250:251], v19 offset:49664
    v_mfma_f32_32x32x16_bf16 v[80:95], v[60:63], v[212:215], v[80:95]
    ds_read_b64_tr_b16 v[252:253], v23 offset:49152
    ds_read_b64_tr_b16 v[254:255], v23 offset:49664
    s_waitcnt vmcnt(2)
    s_barrier
    s_waitcnt lgkmcnt(4)
    v_mfma_f32_32x32x16_bf16 v[64:79], v[240:243], v[216:219], v[64:79]
    s_add_u32 m0, s55, 98304
    ds_read_b128 v[224:227], v12 offset:32768
    ds_read_b64_tr_b16 v[56:57], v16 offset:0
    ds_read_b64_tr_b16 v[58:59], v16 offset:512
    buffer_load_dwordx4 v4, s[12:15], s56 offen lds
    v_mfma_f32_32x32x16_bf16 v[80:95], v[244:247], v[216:219], v[80:95]
    ds_read_b64_tr_b16 v[60:61], v20 offset:0
    ds_read_b64_tr_b16 v[62:63], v20 offset:512
    ds_read_b128 v[228:231], v13 offset:32768
    buffer_load_dwordx4 v[44:47], v11, s[16:19], s45 offen sc1
    s_waitcnt lgkmcnt(6)
    v_mfma_f32_32x32x16_bf16 v[64:79], v[248:251], v[220:223], v[64:79]
    ds_read_b128 v[232:235], v14 offset:32768
    ds_read_b64_tr_b16 v[240:241], v17 offset:0
    ds_read_b64_tr_b16 v[242:243], v17 offset:512
    buffer_load_dwordx4 v10, s[12:15], s56 offen offset:1024 lds
    s_add_u32 s57, s100, 128
    s_sub_u32 s100, s100, 768
    s_min_u32 s100, s100, s57
    s_mul_i32 s56, s100, 1792
    v_mfma_f32_32x32x16_bf16 v[80:95], v[252:255], v[220:223], v[80:95]
    s_add_u32 m0, s76, 131072
    ds_read_b64_tr_b16 v[244:245], v21 offset:0
    ds_read_b64_tr_b16 v[246:247], v21 offset:512
    ds_read_b128 v[236:239], v15 offset:32768
    s_add_u32 s57, s3, 0
    buffer_load_dwordx4 v2, s[24:27], s57 offen offset:0 lds
    s_waitcnt lgkmcnt(7)
    v_mfma_f32_32x32x16_bf16 v[64:79], v[56:59], v[224:227], v[64:79]
    v_mfma_f32_16x16x32_bf16 v[28:31], v[56:59], v[24:27], v[28:31]
    ds_read_b64_tr_b16 v[248:249], v18 offset:0
    ds_read_b64_tr_b16 v[250:251], v18 offset:512
    s_add_u32 s57, s3, 6144
    buffer_load_dwordx4 v2, s[24:27], s57 offen offset:1024 lds
    v_mfma_f32_32x32x16_bf16 v[80:95], v[60:63], v[224:227], v[80:95]
    v_mfma_f32_16x16x32_bf16 v[32:35], v[60:63], v[24:27], v[32:35]
    ds_read_b64_tr_b16 v[252:253], v22 offset:0
    ds_read_b64_tr_b16 v[254:255], v22 offset:512
    s_add_u32 s57, s3, 12288
    buffer_load_dwordx4 v2, s[24:27], s57 offen offset:2048 lds
    s_waitcnt lgkmcnt(5)
    v_mfma_f32_32x32x16_bf16 v[64:79], v[240:243], v[228:231], v[64:79]
    ds_read_b64_tr_b16 v[56:57], v19 offset:0
    ds_read_b64_tr_b16 v[58:59], v19 offset:512
    s_add_u32 s57, s3, 18432
    buffer_load_dwordx4 v2, s[24:27], s57 offen offset:3072 lds
    v_mfma_f32_32x32x16_bf16 v[80:95], v[244:247], v[228:231], v[80:95]
    ds_read_b64_tr_b16 v[60:61], v23 offset:0
    ds_read_b64_tr_b16 v[62:63], v23 offset:512
    s_mov_b32 exec_lo, 0x00030003
    s_mov_b32 exec_hi, 0x00030003
    ds_write_b128 v43, v[28:31] offset:0
    ds_write_b128 v43, v[32:35] offset:512
    s_mov_b64 exec, -1
    s_waitcnt vmcnt(7)
    s_waitcnt lgkmcnt(0)
    s_barrier
    v_mfma_f32_32x32x16_bf16 v[64:79], v[248:251], v[232:235], v[64:79]
    s_add_u32 m0, s55, 114688
    s_nop 0
    buffer_load_dwordx4 v4, s[12:15], s56 offen lds
    s_and_b32 s59, s52, s50
    s_cmp_eq_u32 s59, 1
    s_cselect_b64 s[82:83], -1, 0
    v_cndmask_b32 v16, v16, v20, s[82:83]
    v_cndmask_b32 v17, v17, v21, s[82:83]
    v_cndmask_b32 v18, v18, v22, s[82:83]
    v_cndmask_b32 v19, v19, v23, s[82:83]
    v_mfma_f32_32x32x16_bf16 v[80:95], v[252:255], v[232:235], v[80:95]
    ds_read_b64_tr_b16 v[240:241], v16 offset:16384
    ds_read_b64_tr_b16 v[242:243], v16 offset:16896
    ds_read_b64_tr_b16 v[244:245], v20 offset:16384
    ds_read_b64_tr_b16 v[246:247], v20 offset:16896
    v_mfma_f32_32x32x16_bf16 v[64:79], v[56:59], v[236:239], v[64:79]
    buffer_load_dwordx4 v10, s[12:15], s56 offen offset:1024 lds
    s_add_u32 s57, s100, 128
    s_sub_u32 s100, s100, 768
    s_min_u32 s100, s100, s57
    s_mul_i32 s56, s100, 1792
    ds_read_b64_tr_b16 v[248:249], v17 offset:16384
    ds_read_b64_tr_b16 v[250:251], v17 offset:16896
    ds_read_b64_tr_b16 v[252:253], v21 offset:16384
    ds_read_b64_tr_b16 v[254:255], v21 offset:16896
    v_mfma_f32_32x32x16_bf16 v[80:95], v[60:63], v[236:239], v[80:95]
    s_cmp_eq_u32 s50, 1
    s_cbranch_scc1 L_mlp_ch1
    s_waitcnt lgkmcnt(4)
    v_mfma_f32_32x32x16_bf16 v[96:111], v[240:243], v[128:131], 0
    v_mfma_f32_16x16x32_bf16 v[28:31], v[240:243], v[24:27], 0
    ds_read_b64_tr_b16 v[56:57], v18 offset:16384
    ds_read_b64_tr_b16 v[58:59], v18 offset:16896
    v_mfma_f32_32x32x16_bf16 v[112:127], v[244:247], v[128:131], 0
    v_mfma_f32_16x16x32_bf16 v[32:35], v[244:247], v[24:27], 0
    ds_read_b64_tr_b16 v[60:61], v22 offset:16384
    ds_read_b64_tr_b16 v[62:63], v22 offset:16896
    s_waitcnt lgkmcnt(4)
    v_mfma_f32_32x32x16_bf16 v[96:111], v[248:251], v[132:135], v[96:111]
    ds_read_b64_tr_b16 v[240:241], v19 offset:16384
    ds_read_b64_tr_b16 v[242:243], v19 offset:16896
    v_mfma_f32_32x32x16_bf16 v[112:127], v[252:255], v[132:135], v[112:127]
    ds_read_b64_tr_b16 v[244:245], v23 offset:16384
    ds_read_b64_tr_b16 v[246:247], v23 offset:16896
    s_waitcnt vmcnt(6)
    s_barrier
    s_waitcnt lgkmcnt(4)
    v_mfma_f32_32x32x16_bf16 v[96:111], v[56:59], v[136:139], v[96:111]
    ds_read_b64_tr_b16 v[248:249], v16 offset:32768
    ds_read_b64_tr_b16 v[250:251], v16 offset:33280
    v_and_b32 v48, 31, v1
    v_lshlrev_b32 v48, 2, v48
    s_lshl_b32 s58, s50, 10
    s_add_u32 s58, s58, 49152
    v_add_u32 v48, s58, v48
    ds_read_b32 v128, v48 offset:0
    ds_read_b32 v129, v48 offset:128
    ds_read_b32 v130, v48 offset:256
    ds_read_b32 v131, v48 offset:384
    ds_read_b32 v132, v48 offset:512
    ds_read_b32 v133, v48 offset:640
    ds_read_b32 v134, v48 offset:768
    ds_read_b32 v135, v48 offset:896
    v_mfma_f32_32x32x16_bf16 v[112:127], v[60:63], v[136:139], v[112:127]
    s_add_u32 m0, s55, 65536
    ds_read_b64_tr_b16 v[252:253], v20 offset:32768
    ds_read_b64_tr_b16 v[254:255], v20 offset:33280
    buffer_load_dwordx4 v4, s[12:15], s56 offen lds
    s_waitcnt lgkmcnt(12)
    v_mfma_f32_32x32x16_bf16 v[96:111], v[240:243], v[140:143], v[96:111]
    ds_read_b64_tr_b16 v[56:57], v17 offset:32768
    ds_read_b64_tr_b16 v[58:59], v17 offset:33280
    v_cmp_ne_u32 s[82:83], v6, v47
    s_nop 0
    s_cmp_eq_u64 s[82:83], 0
    s_cbranch_scc0 L_ss_3
L_sb_4:
    v_mfma_f32_32x32x16_bf16 v[112:127], v[244:247], v[140:143], v[112:127]
    ds_read_b64_tr_b16 v[60:61], v21 offset:32768
    ds_read_b64_tr_b16 v[62:63], v21 offset:33280
    buffer_load_dwordx4 v10, s[12:15], s56 offen offset:1024 lds
    s_add_u32 s57, s100, 128
    s_sub_u32 s100, s100, 768
    s_min_u32 s100, s100, s57
    s_mul_i32 s56, s100, 1792
    s_waitcnt lgkmcnt(12)
    v_add_f32 v128, v128, v129
    s_waitcnt lgkmcnt(10)
    v_add_f32 v130, v130, v131
    v_add_f32 v130, v128, v130
    v_cvt_pk_bf16_f32 v128, v130, v130
    v_and_b32 v129, 0xffff0000, v128
    v_sub_f32 v129, v130, v129
    v_lshlrev_b32 v130, 16, v40
    v_cvt_pk_bf16_f32 v129, v129, v130
    s_waitcnt lgkmcnt(4)
    v_mfma_f32_32x32x16_bf16 v[96:111], v[248:251], v[144:147], v[96:111]
    v_mfma_f32_16x16x32_bf16 v[28:31], v[248:251], v[24:27], v[28:31]
    ds_read_b64_tr_b16 v[240:241], v18 offset:32768
    ds_read_b64_tr_b16 v[242:243], v18 offset:33280
    v_cvt_pk_bf16_f32 v130, v130, 0
    v_mov_b32 v131, 0
    v_add_f32 v132, v132, v133
    v_add_f32 v134, v134, v135
    v_add_f32 v134, v132, v134
    v_cvt_pk_bf16_f32 v132, v134, v134
    v_and_b32 v133, 0xffff0000, v132
    v_sub_f32 v133, v134, v133
    v_mfma_f32_32x32x16_bf16 v[112:127], v[252:255], v[144:147], v[112:127]
    s_add_u32 m0, s55, 0
    v_mfma_f32_16x16x32_bf16 v[32:35], v[252:255], v[24:27], v[32:35]
    ds_read_b64_tr_b16 v[244:245], v22 offset:32768
    ds_read_b64_tr_b16 v[246:247], v22 offset:33280
    buffer_load_dwordx4 v4, s[12:15], s56 offen lds
    v_lshlrev_b32 v134, 16, v41
    v_cvt_pk_bf16_f32 v133, v133, v134
    v_cvt_pk_bf16_f32 v134, v134, 0
    v_mov_b32 v135, 0
    v_cvt_pk_bf16_f32 v49, v44, v44
    v_and_b32 v49, 0xffff0000, v49
    v_sub_f32 v49, v44, v49
    v_cvt_pk_bf16_f32 v36, v44, v49
    s_waitcnt lgkmcnt(4)
    v_mfma_f32_32x32x16_bf16 v[96:111], v[56:59], v[148:151], v[96:111]
    ds_read_b64_tr_b16 v[248:249], v19 offset:32768
    ds_read_b64_tr_b16 v[250:251], v19 offset:33280
    v_cvt_pk_bf16_f32 v37, v44, v46
    v_and_b32 v49, 0xffff0000, v37
    v_sub_f32 v49, v46, v49
    v_cvt_pk_bf16_f32 v38, v49, 0
    v_cndmask_b32 v38, 0, v38, s[68:69]
    v_mov_b32 v39, 0
    v_cndmask_b32 v36, 0, v36, s[68:69]
    v_cndmask_b32 v37, 0, v37, s[68:69]
    v_mul_f32 v42, 0x3fb8aa3b, v45
    v_mfma_f32_32x32x16_bf16 v[112:127], v[60:63], v[148:151], v[112:127]
    ds_read_b64_tr_b16 v[252:253], v23 offset:32768
    ds_read_b64_tr_b16 v[254:255], v23 offset:33280
    s_waitcnt vmcnt(3)
    s_barrier
    buffer_load_dwordx4 v10, s[12:15], s56 offen offset:1024 lds
    s_add_u32 s57, s100, 128
    s_sub_u32 s100, s100, 768
    s_min_u32 s100, s100, s57
    s_mul_i32 s56, s100, 1792
    v_mfma_f32_32x32x16_bf16 v[64:79], v[128:131], v[36:39], v[64:79]
    v_add_u32 v44, 6144, v2
    v_add_u32 v45, 12288, v2
    v_add_u32 v46, 18432, v2
    s_waitcnt lgkmcnt(4)
    v_mfma_f32_32x32x16_bf16 v[96:111], v[240:243], v[152:155], v[96:111]
    ds_read_b64_tr_b16 v[56:57], v16 offset:49152
    ds_read_b64_tr_b16 v[58:59], v16 offset:49664
    v_mfma_f32_32x32x16_bf16 v[80:95], v[132:135], v[36:39], v[80:95]
    buffer_load_ushort v40, v0, s[32:35], s63 offen
    buffer_load_ushort v41, v0, s[32:35], s64 offen
    v_mfma_f32_32x32x16_bf16 v[112:127], v[244:247], v[152:155], v[112:127]
    s_add_u32 m0, s55, 16384
    ds_read_b64_tr_b16 v[60:61], v20 offset:49152
    ds_read_b64_tr_b16 v[62:63], v20 offset:49664
    buffer_load_dwordx4 v4, s[12:15], s56 offen lds
    v_mul_f32 v64, v64, v42
    v_mul_f32 v65, v65, v42
    v_mul_f32 v66, v66, v42
    v_mul_f32 v67, v67, v42
    v_exp_f32 v52, v64
    v_exp_f32 v53, v65
    v_exp_f32 v54, v66
    v_exp_f32 v55, v67
    v_fma_f32 v52, v52, s75, s75
    s_waitcnt lgkmcnt(4)
    v_mfma_f32_32x32x16_bf16 v[96:111], v[248:251], v[156:159], v[96:111]
    ds_read_b64_tr_b16 v[240:241], v17 offset:49152
    ds_read_b64_tr_b16 v[242:243], v17 offset:49664
    v_fma_f32 v53, v53, s75, s75
    v_fma_f32 v54, v54, s75, s75
    v_fma_f32 v55, v55, s75, s75
    v_fma_f32 v52, v52, v52, 0.5
    v_fma_f32 v53, v53, v53, 0.5
    v_fma_f32 v54, v54, v54, 0.5
    v_fma_f32 v55, v55, v55, 0.5
    v_rcp_f32 v52, v52
    v_rcp_f32 v53, v53
    v_mfma_f32_32x32x16_bf16 v[112:127], v[252:255], v[156:159], v[112:127]
    ds_read_b64_tr_b16 v[244:245], v21 offset:49152
    ds_read_b64_tr_b16 v[246:247], v21 offset:49664
    buffer_load_dwordx4 v10, s[12:15], s56 offen offset:1024 lds
    s_add_u32 s57, s100, 128
    s_sub_u32 s100, s100, 768
    s_min_u32 s100, s100, s57
    s_mul_i32 s56, s100, 1792
    v_rcp_f32 v54, v54
    v_rcp_f32 v55, v55
    v_fma_f32 v52, -v64, v52, v64
    v_fma_f32 v53, -v65, v53, v65
    v_fma_f32 v54, -v66, v54, v66
    v_fma_f32 v55, -v67, v55, v67
    v_cvt_pk_bf16_f32 v64, v52, v53
    v_cvt_pk_bf16_f32 v65, v54, v55
    v_mul_f32 v68, v68, v42
    v_mul_f32 v69, v69, v42
    s_waitcnt lgkmcnt(4)
    v_mfma_f32_32x32x16_bf16 v[96:111], v[56:59], v[160:163], v[96:111]
    v_mfma_f32_16x16x32_bf16 v[28:31], v[56:59], v[24:27], v[28:31]
    ds_read_b64_tr_b16 v[248:249], v18 offset:49152
    ds_read_b64_tr_b16 v[250:251], v18 offset:49664
    v_mul_f32 v70, v70, v42
    v_mul_f32 v71, v71, v42
    v_exp_f32 v52, v68
    v_exp_f32 v53, v69
    v_exp_f32 v54, v70
    v_exp_f32 v55, v71
    v_fma_f32 v52, v52, s75, s75
    v_fma_f32 v53, v53, s75, s75
    v_fma_f32 v54, v54, s75, s75
    v_mfma_f32_32x32x16_bf16 v[112:127], v[60:63], v[160:163], v[112:127]
    s_add_u32 m0, s55, 32768
    v_mfma_f32_16x16x32_bf16 v[32:35], v[60:63], v[24:27], v[32:35]
    ds_read_b64_tr_b16 v[252:253], v22 offset:49152
    ds_read_b64_tr_b16 v[254:255], v22 offset:49664
    buffer_load_dwordx4 v4, s[12:15], s56 offen lds
    v_fma_f32 v55, v55, s75, s75
    v_fma_f32 v52, v52, v52, 0.5
    v_fma_f32 v53, v53, v53, 0.5
    v_fma_f32 v54, v54, v54, 0.5
    v_fma_f32 v55, v55, v55, 0.5
    v_rcp_f32 v52, v52
    v_rcp_f32 v53, v53
    v_rcp_f32 v54, v54
    v_rcp_f32 v55, v55
    v_fma_f32 v52, -v68, v52, v68
    s_waitcnt lgkmcnt(4)
    v_mfma_f32_32x32x16_bf16 v[96:111], v[240:243], v[164:167], v[96:111]
    ds_read_b64_tr_b16 v[56:57], v19 offset:49152
    ds_read_b64_tr_b16 v[58:59], v19 offset:49664
    v_fma_f32 v53, -v69, v53, v69
    v_fma_f32 v54, -v70, v54, v70
    v_fma_f32 v55, -v71, v55, v71
    v_cvt_pk_bf16_f32 v66, v52, v53
    v_cvt_pk_bf16_f32 v67, v54, v55
    v_mul_f32 v72, v72, v42
    v_mul_f32 v73, v73, v42
    v_mul_f32 v74, v74, v42
    v_mul_f32 v75, v75, v42
    v_mfma_f32_32x32x16_bf16 v[112:127], v[244:247], v[164:167], v[112:127]
    ds_read_b64_tr_b16 v[60:61], v23 offset:49152
    ds_read_b64_tr_b16 v[62:63], v23 offset:49664
    s_waitcnt vmcnt(7)
    s_barrier
    buffer_load_dwordx4 v10, s[12:15], s56 offen offset:1024 lds
    v_exp_f32 v52, v72
    v_exp_f32 v53, v73
    v_exp_f32 v54, v74
    v_exp_f32 v55, v75
    v_fma_f32 v52, v52, s75, s75
    v_fma_f32 v53, v53, s75, s75
    v_fma_f32 v54, v54, s75, s75
    v_fma_f32 v55, v55, s75, s75
    v_fma_f32 v52, v52, v52, 0.5
    v_fma_f32 v53, v53, v53, 0.5
    s_waitcnt lgkmcnt(4)
    v_mfma_f32_32x32x16_bf16 v[96:111], v[248:251], v[168:171], v[96:111]
    ds_read_b64_tr_b16 v[240:241], v16 offset:0
    ds_read_b64_tr_b16 v[242:243], v16 offset:512
    v_fma_f32 v54, v54, v54, 0.5
    v_fma_f32 v55, v55, v55, 0.5
    v_rcp_f32 v52, v52
    v_rcp_f32 v53, v53
    v_rcp_f32 v54, v54
    v_rcp_f32 v55, v55
    v_fma_f32 v52, -v72, v52, v72
    v_fma_f32 v53, -v73, v53, v73
    v_fma_f32 v54, -v74, v54, v74
    v_mfma_f32_32x32x16_bf16 v[112:127], v[252:255], v[168:171], v[112:127]
    ds_read_b64_tr_b16 v[244:245], v20 offset:0
    ds_read_b64_tr_b16 v[246:247], v20 offset:512
    v_fma_f32 v55, -v75, v55, v75
    v_cvt_pk_bf16_f32 v68, v52, v53
    v_cvt_pk_bf16_f32 v69, v54, v55
    v_mul_f32 v76, v76, v42
    v_mul_f32 v77, v77, v42
    v_mul_f32 v78, v78, v42
    v_mul_f32 v79, v79, v42
    v_exp_f32 v52, v76
    v_exp_f32 v53, v77
    v_exp_f32 v54, v78
    s_waitcnt lgkmcnt(4)
    v_mfma_f32_32x32x16_bf16 v[96:111], v[56:59], v[172:175], v[96:111]
    ds_read_b64_tr_b16 v[248:249], v17 offset:0
    ds_read_b64_tr_b16 v[250:251], v17 offset:512
    v_exp_f32 v55, v79
    v_fma_f32 v52, v52, s75, s75
    v_fma_f32 v53, v53, s75, s75
    v_fma_f32 v54, v54, s75, s75
    v_fma_f32 v55, v55, s75, s75
    v_fma_f32 v52, v52, v52, 0.5
    v_fma_f32 v53, v53, v53, 0.5
    v_fma_f32 v54, v54, v54, 0.5
    v_fma_f32 v55, v55, v55, 0.5
    v_mfma_f32_32x32x16_bf16 v[112:127], v[60:63], v[172:175], v[112:127]
    ds_read_b64_tr_b16 v[252:253], v21 offset:0
    ds_read_b64_tr_b16 v[254:255], v21 offset:512
    v_rcp_f32 v52, v52
    v_rcp_f32 v53, v53
    v_rcp_f32 v54, v54
    v_rcp_f32 v55, v55
    v_fma_f32 v52, -v76, v52, v76
    v_fma_f32 v53, -v77, v53, v77
    v_fma_f32 v54, -v78, v54, v78
    v_fma_f32 v55, -v79, v55, v79
    v_cvt_pk_bf16_f32 v70, v52, v53
    v_cvt_pk_bf16_f32 v71, v54, v55
    s_waitcnt lgkmcnt(4)
    v_mfma_f32_32x32x16_bf16 v[96:111], v[240:243], v[176:179], v[96:111]
    v_mfma_f32_16x16x32_bf16 v[28:31], v[240:243], v[24:27], v[28:31]
    ds_read_b64_tr_b16 v[56:57], v18 offset:0
    ds_read_b64_tr_b16 v[58:59], v18 offset:512
    v_subrev_u32 v16, 65536, v16
    buffer_store_dwordx4 v[64:67], v5, s[16:19], s71 offen offset:0 sc1
    buffer_store_dwordx4 v[68:71], v5, s[16:19], s71 offen offset:1024 sc1
    v_mul_f32 v80, v80, v42
    v_mul_f32 v81, v81, v42
    v_mul_f32 v82, v82, v42
    v_mul_f32 v83, v83, v42
    v_exp_f32 v52, v80
    v_exp_f32 v53, v81
    v_exp_f32 v54, v82
    v_mfma_f32_32x32x16_bf16 v[112:127], v[244:247], v[176:179], v[112:127]
    v_mfma_f32_16x16x32_bf16 v[32:35], v[244:247], v[24:27], v[32:35]
    ds_read_b64_tr_b16 v[60:61], v22 offset:0
    ds_read_b64_tr_b16 v[62:63], v22 offset:512
    v_subrev_u32 v20, 65536, v20
    v_exp_f32 v55, v83
    v_fma_f32 v52, v52, s75, s75
    v_fma_f32 v53, v53, s75, s75
    v_fma_f32 v54, v54, s75, s75
    v_fma_f32 v55, v55, s75, s75
    v_fma_f32 v52, v52, v52, 0.5
    v_fma_f32 v53, v53, v53, 0.5
    s_waitcnt lgkmcnt(4)
    v_mfma_f32_32x32x16_bf16 v[96:111], v[248:251], v[180:183], v[96:111]
    ds_read_b64_tr_b16 v[240:241], v19 offset:0
    ds_read_b64_tr_b16 v[242:243], v19 offset:512
    v_subrev_u32 v17, 65536, v17
    v_fma_f32 v54, v54, v54, 0.5
    v_fma_f32 v55, v55, v55, 0.5
    v_rcp_f32 v52, v52
    v_rcp_f32 v53, v53
    v_rcp_f32 v54, v54
    v_rcp_f32 v55, v55
    v_fma_f32 v52, -v80, v52, v80
    v_fma_f32 v53, -v81, v53, v81
    v_mfma_f32_32x32x16_bf16 v[112:127], v[252:255], v[180:183], v[112:127]
    ds_read_b64_tr_b16 v[244:245], v23 offset:0
    ds_read_b64_tr_b16 v[246:247], v23 offset:512
    s_waitcnt vmcnt(8)
    s_barrier
    v_subrev_u32 v21, 65536, v21
    v_fma_f32 v54, -v82, v54, v82
    v_fma_f32 v55, -v83, v55, v83
    v_cvt_pk_bf16_f32 v80, v52, v53
    v_cvt_pk_bf16_f32 v81, v54, v55
    v_mul_f32 v84, v84, v42
    v_mul_f32 v85, v85, v42
    v_mul_f32 v86, v86, v42
    s_waitcnt lgkmcnt(4)
    v_mfma_f32_32x32x16_bf16 v[96:111], v[56:59], v[184:187], v[96:111]
    ds_read_b64_tr_b16 v[248:249], v16 offset:0
    ds_read_b64_tr_b16 v[250:251], v16 offset:512
    v_subrev_u32 v18, 65536, v18
    v_mul_f32 v87, v87, v42
    v_exp_f32 v52, v84
    v_exp_f32 v53, v85
    v_exp_f32 v54, v86
    v_exp_f32 v55, v87
    v_fma_f32 v52, v52, s75, s75
    v_fma_f32 v53, v53, s75, s75
    v_fma_f32 v54, v54, s75, s75
    v_mfma_f32_32x32x16_bf16 v[112:127], v[60:63], v[184:187], v[112:127]
    s_add_u32 m0, s76, 98304
    ds_read_b64_tr_b16 v[252:253], v20 offset:0
    ds_read_b64_tr_b16 v[254:255], v20 offset:512
    s_add_u32 s57, s3, 57344
    buffer_load_dwordx4 v2, s[24:27], s57 offen offset:0 lds
    v_subrev_u32 v22, 65536, v22
    v_fma_f32 v55, v55, s75, s75
    v_fma_f32 v52, v52, v52, 0.5
    v_fma_f32 v53, v53, v53, 0.5
    v_fma_f32 v54, v54, v54, 0.5
    v_fma_f32 v55, v55, v55, 0.5
    v_rcp_f32 v52, v52
    v_rcp_f32 v53, v53
    s_waitcnt lgkmcnt(4)
    v_mfma_f32_32x32x16_bf16 v[96:111], v[240:243], v[188:191], v[96:111]
    ds_read_b64_tr_b16 v[56:57], v17 offset:0
    ds_read_b64_tr_b16 v[58:59], v17 offset:512
    v_subrev_u32 v19, 65536, v19
    v_rcp_f32 v54, v54
    v_rcp_f32 v55, v55
    v_fma_f32 v52, -v84, v52, v84
    v_fma_f32 v53, -v85, v53, v85
    v_fma_f32 v54, -v86, v54, v86
    v_fma_f32 v55, -v87, v55, v87
    v_cvt_pk_bf16_f32 v82, v52, v53
    v_cvt_pk_bf16_f32 v83, v54, v55
    v_mfma_f32_32x32x16_bf16 v[112:127], v[244:247], v[188:191], v[112:127]
    ds_read_b64_tr_b16 v[60:61], v21 offset:0
    ds_read_b64_tr_b16 v[62:63], v21 offset:512
    buffer_load_dwordx4 v44, s[24:27], s57 offen offset:1024 lds
    v_subrev_u32 v23, 65536, v23
    v_mul_f32 v88, v88, v42
    v_mul_f32 v89, v89, v42
    v_mul_f32 v90, v90, v42
    v_mul_f32 v91, v91, v42
    v_exp_f32 v52, v88
    v_exp_f32 v53, v89
    v_exp_f32 v54, v90
    s_waitcnt lgkmcnt(4)
    v_mfma_f32_32x32x16_bf16 v[96:111], v[248:251], v[192:195], v[96:111]
    v_mfma_f32_16x16x32_bf16 v[28:31], v[248:251], v[24:27], v[28:31]
    ds_read_b64_tr_b16 v[240:241], v18 offset:0
    ds_read_b64_tr_b16 v[242:243], v18 offset:512
    v_exp_f32 v55, v91
    v_fma_f32 v52, v52, s75, s75
    v_fma_f32 v53, v53, s75, s75
    v_fma_f32 v54, v54, s75, s75
    v_fma_f32 v55, v55, s75, s75
    v_fma_f32 v52, v52, v52, 0.5
    v_fma_f32 v53, v53, v53, 0.5
    v_mfma_f32_32x32x16_bf16 v[112:127], v[252:255], v[192:195], v[112:127]
    v_mfma_f32_16x16x32_bf16 v[32:35], v[252:255], v[24:27], v[32:35]
    ds_read_b64_tr_b16 v[244:245], v22 offset:0
    ds_read_b64_tr_b16 v[246:247], v22 offset:512
    buffer_load_dwordx4 v45, s[24:27], s57 offen offset:2048 lds
    v_fma_f32 v54, v54, v54, 0.5
    v_fma_f32 v55, v55, v55, 0.5
    v_rcp_f32 v52, v52
    v_rcp_f32 v53, v53
    v_rcp_f32 v54, v54
    v_rcp_f32 v55, v55
    v_fma_f32 v52, -v88, v52, v88
    v_fma_f32 v53, -v89, v53, v89
    s_waitcnt lgkmcnt(4)
    v_mfma_f32_32x32x16_bf16 v[96:111], v[56:59], v[196:199], v[96:111]
    ds_read_b64_tr_b16 v[248:249], v19 offset:0
    ds_read_b64_tr_b16 v[250:251], v19 offset:512
    v_fma_f32 v54, -v90, v54, v90
    v_fma_f32 v55, -v91, v55, v91
    v_cvt_pk_bf16_f32 v84, v52, v53
    v_cvt_pk_bf16_f32 v85, v54, v55
    v_mul_f32 v92, v92, v42
    v_mul_f32 v93, v93, v42
    v_mul_f32 v94, v94, v42
    v_mfma_f32_32x32x16_bf16 v[112:127], v[60:63], v[196:199], v[112:127]
    ds_read_b64_tr_b16 v[252:253], v23 offset:0
    ds_read_b64_tr_b16 v[254:255], v23 offset:512
    s_waitcnt vmcnt(7)
    s_barrier
    buffer_load_dwordx4 v46, s[24:27], s57 offen offset:3072 lds
    v_mul_f32 v95, v95, v42
    v_exp_f32 v52, v92
    v_exp_f32 v53, v93
    v_exp_f32 v54, v94
    v_exp_f32 v55, v95
    v_fma_f32 v52, v52, s75, s75
    v_fma_f32 v53, v53, s75, s75
    v_fma_f32 v54, v54, s75, s75
    s_waitcnt lgkmcnt(4)
    v_mfma_f32_32x32x16_bf16 v[96:111], v[240:243], v[200:203], v[96:111]
    ds_read_b64_tr_b16 v[56:57], v16 offset:16384
    ds_read_b64_tr_b16 v[58:59], v16 offset:16896
    v_fma_f32 v55, v55, s75, s75
    v_fma_f32 v52, v52, v52, 0.5
    v_fma_f32 v53, v53, v53, 0.5
    v_fma_f32 v54, v54, v54, 0.5
    v_fma_f32 v55, v55, v55, 0.5
    v_rcp_f32 v52, v52
    v_rcp_f32 v53, v53
    v_mfma_f32_32x32x16_bf16 v[112:127], v[244:247], v[200:203], v[112:127]
    s_add_u32 m0, s76, 65536
    ds_read_b64_tr_b16 v[60:61], v20 offset:16384
    ds_read_b64_tr_b16 v[62:63], v20 offset:16896
    s_add_u32 s57, s3, 229376
    buffer_load_dwordx4 v2, s[24:27], s57 offen offset:0 lds
    v_rcp_f32 v54, v54
    v_rcp_f32 v55, v55
    v_fma_f32 v52, -v92, v52, v92
    v_fma_f32 v53, -v93, v53, v93
    v_fma_f32 v54, -v94, v54, v94
    v_fma_f32 v55, -v95, v55, v95
    v_cvt_pk_bf16_f32 v86, v52, v53
    v_cvt_pk_bf16_f32 v87, v54, v55
    s_waitcnt lgkmcnt(4)
    v_mfma_f32_32x32x16_bf16 v[96:111], v[248:251], v[204:207], v[96:111]
    ds_read_b64_tr_b16 v[240:241], v17 offset:16384
    ds_read_b64_tr_b16 v[242:243], v17 offset:16896
    buffer_store_dwordx4 v[80:83], v5, s[16:19], s72 offen offset:0 sc1
    buffer_store_dwordx4 v[84:87], v5, s[16:19], s72 offen offset:1024 sc1
    v_mfma_f32_32x32x16_bf16 v[112:127], v[252:255], v[204:207], v[112:127]
    ds_read_b64_tr_b16 v[244:245], v21 offset:16384
    ds_read_b64_tr_b16 v[246:247], v21 offset:16896
    buffer_load_dwordx4 v44, s[24:27], s57 offen offset:1024 lds
    s_waitcnt lgkmcnt(4)
    v_mfma_f32_32x32x16_bf16 v[96:111], v[56:59], v[208:211], v[96:111]
    v_mfma_f32_16x16x32_bf16 v[28:31], v[56:59], v[24:27], v[28:31]
    ds_read_b64_tr_b16 v[248:249], v18 offset:16384
    ds_read_b64_tr_b16 v[250:251], v18 offset:16896
    v_mfma_f32_32x32x16_bf16 v[112:127], v[60:63], v[208:211], v[112:127]
    v_mfma_f32_16x16x32_bf16 v[32:35], v[60:63], v[24:27], v[32:35]
    ds_read_b64_tr_b16 v[252:253], v22 offset:16384
    ds_read_b64_tr_b16 v[254:255], v22 offset:16896
    buffer_load_dwordx4 v45, s[24:27], s57 offen offset:2048 lds
    s_waitcnt lgkmcnt(4)
    v_mfma_f32_32x32x16_bf16 v[96:111], v[240:243], v[212:215], v[96:111]
    ds_read_b64_tr_b16 v[56:57], v19 offset:16384
    ds_read_b64_tr_b16 v[58:59], v19 offset:16896
    v_mfma_f32_32x32x16_bf16 v[112:127], v[244:247], v[212:215], v[112:127]
    ds_read_b64_tr_b16 v[60:61], v23 offset:16384
    ds_read_b64_tr_b16 v[62:63], v23 offset:16896
    s_waitcnt vmcnt(11)
    s_barrier
    buffer_load_dwordx4 v46, s[24:27], s57 offen offset:3072 lds
    s_waitcnt lgkmcnt(4)
    v_mfma_f32_32x32x16_bf16 v[96:111], v[248:251], v[216:219], v[96:111]
    ds_read_b64_tr_b16 v[240:241], v16 offset:32768
    ds_read_b64_tr_b16 v[242:243], v16 offset:33280
    v_mfma_f32_32x32x16_bf16 v[112:127], v[252:255], v[216:219], v[112:127]
    ds_read_b64_tr_b16 v[244:245], v20 offset:32768
    ds_read_b64_tr_b16 v[246:247], v20 offset:33280
    s_waitcnt lgkmcnt(4)
    v_mfma_f32_32x32x16_bf16 v[96:111], v[56:59], v[220:223], v[96:111]
    ds_read_b64_tr_b16 v[248:249], v17 offset:32768
    ds_read_b64_tr_b16 v[250:251], v17 offset:33280
    v_mfma_f32_32x32x16_bf16 v[112:127], v[60:63], v[220:223], v[112:127]
    ds_read_b64_tr_b16 v[252:253], v21 offset:32768
    ds_read_b64_tr_b16 v[254:255], v21 offset:33280
    s_waitcnt lgkmcnt(4)
    v_mfma_f32_32x32x16_bf16 v[96:111], v[240:243], v[224:227], v[96:111]
    v_mfma_f32_16x16x32_bf16 v[28:31], v[240:243], v[24:27], v[28:31]
    ds_read_b64_tr_b16 v[56:57], v18 offset:32768
    ds_read_b64_tr_b16 v[58:59], v18 offset:33280
    v_mfma_f32_32x32x16_bf16 v[112:127], v[244:247], v[224:227], v[112:127]
    v_mfma_f32_16x16x32_bf16 v[32:35], v[244:247], v[24:27], v[32:35]
    ds_read_b64_tr_b16 v[60:61], v22 offset:32768
    ds_read_b64_tr_b16 v[62:63], v22 offset:33280
    s_waitcnt lgkmcnt(4)
    v_mfma_f32_32x32x16_bf16 v[96:111], v[248:251], v[228:231], v[96:111]
    ds_read_b64_tr_b16 v[240:241], v19 offset:32768
    ds_read_b64_tr_b16 v[242:243], v19 offset:33280
    v_mfma_f32_32x32x16_bf16 v[112:127], v[252:255], v[228:231], v[112:127]
    ds_read_b64_tr_b16 v[244:245], v23 offset:32768
    ds_read_b64_tr_b16 v[246:247], v23 offset:33280
    s_mov_b32 exec_lo, 0x00030003
    s_mov_b32 exec_hi, 0x00030003
    ds_write_b128 v43, v[28:31] offset:2048
    ds_write_b128 v43, v[32:35] offset:2560
    s_mov_b64 exec, -1
    s_waitcnt lgkmcnt(0)
    s_barrier
    v_and_b32 v48, 31, v1
    v_lshlrev_b32 v48, 2, v48
    s_lshl_b32 s58, s50, 10
    s_add_u32 s58, s58, 49152
    v_add_u32 v48, s58, v48
    ds_read_b32 v28, v48 offset:2048
    ds_read_b32 v29, v48 offset:2176
    ds_read_b32 v30, v48 offset:2304
    ds_read_b32 v31, v48 offset:2432
    ds_read_b32 v32, v48 offset:2560
    ds_read_b32 v33, v48 offset:2688
    ds_read_b32 v34, v48 offset:2816
    ds_read_b32 v35, v48 offset:2944
    v_mfma_f32_32x32x16_bf16 v[96:111], v[56:59], v[232:235], v[96:111]
    s_add_u32 m0, s76, 0
    s_add_u32 s57, s3, 286720
    buffer_load_dwordx4 v2, s[24:27], s57 offen offset:0 lds
    v_mfma_f32_32x32x16_bf16 v[112:127], v[60:63], v[232:235], v[112:127]
    buffer_load_dwordx4 v44, s[24:27], s57 offen offset:1024 lds
    s_waitcnt lgkmcnt(6)
    v_add_f32 v28, v28, v29
    s_waitcnt lgkmcnt(4)
    v_add_f32 v30, v30, v31
    v_add_f32 v30, v28, v30
    v_cvt_pk_bf16_f32 v28, v30, v30
    v_and_b32 v29, 0xffff0000, v28
    v_sub_f32 v29, v30, v29
    v_mfma_f32_32x32x16_bf16 v[96:111], v[240:243], v[236:239], v[96:111]
    buffer_load_dwordx4 v45, s[24:27], s57 offen offset:2048 lds
    s_waitcnt vmcnt(6)
    s_mov_b64 exec, 1
    buffer_store_dwordx2 v[6:7], off, s[16:19], s101 offset:0 sc1
    s_mov_b64 exec, -1
    v_lshlrev_b32 v30, 16, v40
    v_cvt_pk_bf16_f32 v29, v29, v30
    v_cvt_pk_bf16_f32 v30, v30, 0
    v_mov_b32 v31, 0
    s_waitcnt lgkmcnt(2)
    v_add_f32 v32, v32, v33
    s_waitcnt lgkmcnt(0)
    v_add_f32 v34, v34, v35
    v_add_f32 v34, v32, v34
    v_mfma_f32_32x32x16_bf16 v[112:127], v[244:247], v[236:239], v[112:127]
    buffer_load_dwordx4 v46, s[24:27], s57 offen offset:3072 lds
    v_cvt_pk_bf16_f32 v32, v34, v34
    v_and_b32 v33, 0xffff0000, v32
    v_sub_f32 v33, v34, v33
    v_lshlrev_b32 v34, 16, v41
    v_cvt_pk_bf16_f32 v33, v33, v34
    v_cvt_pk_bf16_f32 v34, v34, 0
    v_mov_b32 v35, 0
    v_mfma_f32_32x32x16_bf16 v[96:111], v[28:31], v[36:39], v[96:111]
    s_nop 0
    v_mfma_f32_32x32x16_bf16 v[112:127], v[32:35], v[36:39], v[112:127]
    v_mov_b32 v20, v42
    v_mov_b32 v21, v42
    v_mov_b32 v12, s75
    v_mov_b32 v13, s75
    v_mov_b32 v14, 0.5
    v_mov_b32 v15, 0.5
    s_barrier
    s_add_u32 s57, s3, 114688
    s_add_u32 m0, s76, 32768
    s_nop 0
    buffer_load_dwordx4 v2, s[24:27], s57 offen offset:0 lds
    buffer_load_dwordx4 v44, s[24:27], s57 offen offset:1024 lds
    buffer_load_dwordx4 v45, s[24:27], s57 offen offset:2048 lds
    buffer_load_dwordx4 v46, s[24:27], s57 offen offset:3072 lds
    v_pk_mul_f32 v[96:97], v[96:97], v[20:21]
    v_pk_mul_f32 v[98:99], v[98:99], v[20:21]
    v_pk_mul_f32 v[100:101], v[100:101], v[20:21]
    v_pk_mul_f32 v[102:103], v[102:103], v[20:21]
    v_exp_f32 v48, v96
    v_exp_f32 v49, v97
    v_exp_f32 v50, v98
    v_exp_f32 v51, v99
    v_exp_f32 v52, v100
    v_exp_f32 v53, v101
    v_exp_f32 v54, v102
    v_exp_f32 v55, v103
    v_pk_fma_f32 v[48:49], v[48:49], v[12:13], v[12:13]
    v_pk_fma_f32 v[50:51], v[50:51], v[12:13], v[12:13]
    v_pk_fma_f32 v[52:53], v[52:53], v[12:13], v[12:13]
    v_pk_fma_f32 v[54:55], v[54:55], v[12:13], v[12:13]
    v_pk_fma_f32 v[48:49], v[48:49], v[48:49], v[14:15]
    v_pk_fma_f32 v[50:51], v[50:51], v[50:51], v[14:15]
    v_pk_fma_f32 v[52:53], v[52:53], v[52:53], v[14:15]
    v_pk_fma_f32 v[54:55], v[54:55], v[54:55], v[14:15]
    v_rcp_f32 v48, v48
    v_rcp_f32 v49, v49
    v_rcp_f32 v50, v50
    v_rcp_f32 v51, v51
    v_rcp_f32 v52, v52
    v_rcp_f32 v53, v53
    v_rcp_f32 v54, v54
    v_rcp_f32 v55, v55
    v_pk_fma_f32 v[48:49], v[96:97], v[48:49], v[96:97] neg_lo:[1,0,0] neg_hi:[1,0,0]
    v_pk_fma_f32 v[50:51], v[98:99], v[50:51], v[98:99] neg_lo:[1,0,0] neg_hi:[1,0,0]
    v_pk_fma_f32 v[52:53], v[100:101], v[52:53], v[100:101] neg_lo:[1,0,0] neg_hi:[1,0,0]
    v_pk_fma_f32 v[54:55], v[102:103], v[54:55], v[102:103] neg_lo:[1,0,0] neg_hi:[1,0,0]
    v_cvt_pk_bf16_f32 v96, v48, v49
    v_cvt_pk_bf16_f32 v97, v50, v51
    v_cvt_pk_bf16_f32 v98, v52, v53
    v_cvt_pk_bf16_f32 v99, v54, v55
    v_pk_mul_f32 v[104:105], v[104:105], v[20:21]
    v_pk_mul_f32 v[106:107], v[106:107], v[20:21]
    v_pk_mul_f32 v[108:109], v[108:109], v[20:21]
    v_pk_mul_f32 v[110:111], v[110:111], v[20:21]
    v_exp_f32 v48, v104
    v_exp_f32 v49, v105
    v_exp_f32 v50, v106
    v_exp_f32 v51, v107
    v_exp_f32 v52, v108
    v_exp_f32 v53, v109
    v_exp_f32 v54, v110
    v_exp_f32 v55, v111
    v_pk_fma_f32 v[48:49], v[48:49], v[12:13], v[12:13]
    v_pk_fma_f32 v[50:51], v[50:51], v[12:13], v[12:13]
    v_pk_fma_f32 v[52:53], v[52:53], v[12:13], v[12:13]
    v_pk_fma_f32 v[54:55], v[54:55], v[12:13], v[12:13]
    v_pk_fma_f32 v[48:49], v[48:49], v[48:49], v[14:15]
    v_pk_fma_f32 v[50:51], v[50:51], v[50:51], v[14:15]
    v_pk_fma_f32 v[52:53], v[52:53], v[52:53], v[14:15]
    v_pk_fma_f32 v[54:55], v[54:55], v[54:55], v[14:15]
    v_rcp_f32 v48, v48
    v_rcp_f32 v49, v49
    v_rcp_f32 v50, v50
    v_rcp_f32 v51, v51
    v_rcp_f32 v52, v52
    v_rcp_f32 v53, v53
    v_rcp_f32 v54, v54
    v_rcp_f32 v55, v55
    v_pk_fma_f32 v[48:49], v[104:105], v[48:49], v[104:105] neg_lo:[1,0,0] neg_hi:[1,0,0]
    v_pk_fma_f32 v[50:51], v[106:107], v[50:51], v[106:107] neg_lo:[1,0,0] neg_hi:[1,0,0]
    v_pk_fma_f32 v[52:53], v[108:109], v[52:53], v[108:109] neg_lo:[1,0,0] neg_hi:[1,0,0]
    v_pk_fma_f32 v[54:55], v[110:111], v[54:55], v[110:111] neg_lo:[1,0,0] neg_hi:[1,0,0]
    v_cvt_pk_bf16_f32 v100, v48, v49
    v_cvt_pk_bf16_f32 v101, v50, v51
    v_cvt_pk_bf16_f32 v102, v52, v53
    v_cvt_pk_bf16_f32 v103, v54, v55
    buffer_store_dwordx4 v[96:99], v5, s[16:19], s73 offen offset:0 sc1
    buffer_store_dwordx4 v[100:103], v5, s[16:19], s73 offen offset:1024 sc1
    v_pk_mul_f32 v[112:113], v[112:113], v[20:21]
    v_pk_mul_f32 v[114:115], v[114:115], v[20:21]
    v_pk_mul_f32 v[116:117], v[116:117], v[20:21]
    v_pk_mul_f32 v[118:119], v[118:119], v[20:21]
    v_exp_f32 v48, v112
    v_exp_f32 v49, v113
    v_exp_f32 v50, v114
    v_exp_f32 v51, v115
    v_exp_f32 v52, v116
    v_exp_f32 v53, v117
    v_exp_f32 v54, v118
    v_exp_f32 v55, v119
    v_pk_fma_f32 v[48:49], v[48:49], v[12:13], v[12:13]
    v_pk_fma_f32 v[50:51], v[50:51], v[12:13], v[12:13]
    v_pk_fma_f32 v[52:53], v[52:53], v[12:13], v[12:13]
    v_pk_fma_f32 v[54:55], v[54:55], v[12:13], v[12:13]
    v_pk_fma_f32 v[48:49], v[48:49], v[48:49], v[14:15]
    v_pk_fma_f32 v[50:51], v[50:51], v[50:51], v[14:15]
    v_pk_fma_f32 v[52:53], v[52:53], v[52:53], v[14:15]
    v_pk_fma_f32 v[54:55], v[54:55], v[54:55], v[14:15]
    v_rcp_f32 v48, v48
    v_rcp_f32 v49, v49
    v_rcp_f32 v50, v50
    v_rcp_f32 v51, v51
    v_rcp_f32 v52, v52
    v_rcp_f32 v53, v53
    v_rcp_f32 v54, v54
    v_rcp_f32 v55, v55
    v_pk_fma_f32 v[48:49], v[112:113], v[48:49], v[112:113] neg_lo:[1,0,0] neg_hi:[1,0,0]
    v_pk_fma_f32 v[50:51], v[114:115], v[50:51], v[114:115] neg_lo:[1,0,0] neg_hi:[1,0,0]
    v_pk_fma_f32 v[52:53], v[116:117], v[52:53], v[116:117] neg_lo:[1,0,0] neg_hi:[1,0,0]
    v_pk_fma_f32 v[54:55], v[118:119], v[54:55], v[118:119] neg_lo:[1,0,0] neg_hi:[1,0,0]
    v_cvt_pk_bf16_f32 v112, v48, v49
    v_cvt_pk_bf16_f32 v113, v50, v51
    v_cvt_pk_bf16_f32 v114, v52, v53
    v_cvt_pk_bf16_f32 v115, v54, v55
    v_pk_mul_f32 v[120:121], v[120:121], v[20:21]
    v_pk_mul_f32 v[122:123], v[122:123], v[20:21]
    v_pk_mul_f32 v[124:125], v[124:125], v[20:21]
    v_pk_mul_f32 v[126:127], v[126:127], v[20:21]
    v_exp_f32 v48, v120
    v_exp_f32 v49, v121
    v_exp_f32 v50, v122
    v_exp_f32 v51, v123
    v_exp_f32 v52, v124
    v_exp_f32 v53, v125
    v_exp_f32 v54, v126
    v_exp_f32 v55, v127
    v_pk_fma_f32 v[48:49], v[48:49], v[12:13], v[12:13]
    v_pk_fma_f32 v[50:51], v[50:51], v[12:13], v[12:13]
    v_pk_fma_f32 v[52:53], v[52:53], v[12:13], v[12:13]
    v_pk_fma_f32 v[54:55], v[54:55], v[12:13], v[12:13]
    v_pk_fma_f32 v[48:49], v[48:49], v[48:49], v[14:15]
    v_pk_fma_f32 v[50:51], v[50:51], v[50:51], v[14:15]
    v_pk_fma_f32 v[52:53], v[52:53], v[52:53], v[14:15]
    v_pk_fma_f32 v[54:55], v[54:55], v[54:55], v[14:15]
    v_rcp_f32 v48, v48
    v_rcp_f32 v49, v49
    v_rcp_f32 v50, v50
    v_rcp_f32 v51, v51
    v_rcp_f32 v52, v52
    v_rcp_f32 v53, v53
    v_rcp_f32 v54, v54
    v_rcp_f32 v55, v55
    v_pk_fma_f32 v[48:49], v[120:121], v[48:49], v[120:121] neg_lo:[1,0,0] neg_hi:[1,0,0]
    v_pk_fma_f32 v[50:51], v[122:123], v[50:51], v[122:123] neg_lo:[1,0,0] neg_hi:[1,0,0]
    v_pk_fma_f32 v[52:53], v[124:125], v[52:53], v[124:125] neg_lo:[1,0,0] neg_hi:[1,0,0]
    v_pk_fma_f32 v[54:55], v[126:127], v[54:55], v[126:127] neg_lo:[1,0,0] neg_hi:[1,0,0]
    v_cvt_pk_bf16_f32 v116, v48, v49
    v_cvt_pk_bf16_f32 v117, v50, v51
    v_cvt_pk_bf16_f32 v118, v52, v53
    v_cvt_pk_bf16_f32 v119, v54, v55
    buffer_store_dwordx4 v[112:115], v5, s[16:19], s74 offen offset:0 sc1
    buffer_store_dwordx4 v[116:119], v5, s[16:19], s74 offen offset:1024 sc1
    buffer_load_dwordx2 v[10:11], v9, s[16:19], s77 offen offset:0 sc1
    v_lshrrev_b32 v48, 5, v1
    v_bfe_u32 v49, v1, 2, 2
    v_lshl_add_u32 v48, v48, 2, v49
    v_lshlrev_b32 v48, 7, v48
    v_bfe_u32 v50, v1, 4, 1
    v_lshlrev_b32 v50, 5, v50
    v_and_b32 v51, 3, v1
    v_lshl_add_u32 v50, v51, 3, v50
    v_lshrrev_b32 v49, 1, v49
    v_lshlrev_b32 v49, 6, v49
    v_xor_b32 v50, v50, v49
    v_add_u32 v48, v48, v50
    v_add_u32 v12, s76, v48
    v_and_b32 v12, 0xffffefff, v12
    v_xor_b32 v13, 64, v12
    v_add_u32 v14, 0x10000, v12
    v_add_u32 v15, 0x10000, v13
    v_add_u32 v16, 0x20000, v12
    v_add_u32 v17, 0x20000, v13
    v_and_b32 v48, 31, v1
    v_mul_u32_u24 v48, 896, v48
    v_lshrrev_b32 v49, 5, v1
    v_lshl_add_u32 v18, v49, 4, v48
    buffer_load_dwordx4 v[20:23], v18, s[8:11], s7 offen
    s_mov_b32 s75, 0x3f317218
    s_waitcnt vmcnt(2)
    s_mov_b64 exec, 1
    buffer_store_dwordx2 v[6:7], off, s[16:19], s101 offset:128 sc1
    s_mov_b64 exec, -1
    s_waitcnt vmcnt(2)
    v_cmp_ne_u64 s[82:83], v[6:7], v[10:11]
    s_nop 0
    s_cmp_eq_u64 s[82:83], 0
    s_cbranch_scc0 L_ps_5
L_pb_6:
    s_add_u32 s57, s5, 0
    buffer_load_dwordx4 v[128:131], v5, s[16:19], s57 offen offset:0 sc1
    buffer_load_dwordx4 v[132:135], v5, s[16:19], s57 offen offset:1024 sc1
    buffer_load_dwordx4 v[136:139], v5, s[16:19], s57 offen offset:2048 sc1
    buffer_load_dwordx4 v[140:143], v5, s[16:19], s57 offen offset:3072 sc1
    s_add_u32 s57, s5, 4096
    buffer_load_dwordx4 v[144:147], v5, s[16:19], s57 offen offset:0 sc1
    buffer_load_dwordx4 v[148:151], v5, s[16:19], s57 offen offset:1024 sc1
    buffer_load_dwordx4 v[152:155], v5, s[16:19], s57 offen offset:2048 sc1
    buffer_load_dwordx4 v[156:159], v5, s[16:19], s57 offen offset:3072 sc1
    s_add_u32 s57, s5, 16384
    buffer_load_dwordx4 v[160:163], v5, s[16:19], s57 offen offset:0 sc1
    buffer_load_dwordx4 v[164:167], v5, s[16:19], s57 offen offset:1024 sc1
    buffer_load_dwordx4 v[168:171], v5, s[16:19], s57 offen offset:2048 sc1
    buffer_load_dwordx4 v[172:175], v5, s[16:19], s57 offen offset:3072 sc1
    s_add_u32 s57, s5, 20480
    buffer_load_dwordx4 v[176:179], v5, s[16:19], s57 offen offset:0 sc1
    buffer_load_dwordx4 v[180:183], v5, s[16:19], s57 offen offset:1024 sc1
    buffer_load_dwordx4 v[184:187], v5, s[16:19], s57 offen offset:2048 sc1
    buffer_load_dwordx4 v[188:191], v5, s[16:19], s57 offen offset:3072 sc1
    s_nop 1
    s_branch L_ph2
    s_nop 9
L_mlp_ch1:
    s_waitcnt lgkmcnt(6)
    v_mfma_f32_32x32x16_bf16 v[96:111], v[240:243], v[128:131], 0
    v_mfma_f32_16x16x32_bf16 v[28:31], v[240:243], v[24:27], 0
    ds_read_b64_tr_b16 v[56:57], v18 offset:16384
    ds_read_b64_tr_b16 v[58:59], v18 offset:16896
    s_waitcnt lgkmcnt(4)
    v_mfma_f32_32x32x16_bf16 v[96:111], v[248:251], v[132:135], v[96:111]
    ds_read_b64_tr_b16 v[240:241], v19 offset:16384
    ds_read_b64_tr_b16 v[242:243], v19 offset:16896
    s_waitcnt vmcnt(6)
    s_barrier
    s_waitcnt lgkmcnt(2)
    v_mfma_f32_32x32x16_bf16 v[96:111], v[56:59], v[136:139], v[96:111]
    s_add_u32 m0, s55, 65536
    ds_read_b64_tr_b16 v[248:249], v16 offset:32768
    ds_read_b64_tr_b16 v[250:251], v16 offset:33280
    buffer_load_dwordx4 v4, s[12:15], s56 offen lds
    v_and_b32 v48, 31, v1
    v_lshlrev_b32 v48, 2, v48
    s_lshl_b32 s58, s50, 10
    s_add_u32 s58, s58, 49152
    v_add_u32 v48, s58, v48
    ds_read_b32 v128, v48 offset:0
    ds_read_b32 v129, v48 offset:128
    ds_read_b32 v130, v48 offset:256
    ds_read_b32 v131, v48 offset:384
    ds_read_b32 v132, v48 offset:512
    ds_read_b32 v133, v48 offset:640
    ds_read_b32 v134, v48 offset:768
    ds_read_b32 v135, v48 offset:896
    s_waitcnt lgkmcnt(10)
    v_mfma_f32_32x32x16_bf16 v[96:111], v[240:243], v[140:143], v[96:111]
    ds_read_b64_tr_b16 v[56:57], v17 offset:32768
    ds_read_b64_tr_b16 v[58:59], v17 offset:33280
    buffer_load_dwordx4 v10, s[12:15], s56 offen offset:1024 lds
    s_add_u32 s57, s100, 128
    s_sub_u32 s100, s100, 768
    s_min_u32 s100, s100, s57
    s_mul_i32 s56, s100, 1792
    v_cmp_ne_u32 s[82:83], v6, v47
    s_nop 0
    s_cmp_eq_u64 s[82:83], 0
    s_cbranch_scc0 L_ss_8
L_sb_9:
    s_waitcnt lgkmcnt(8)
    v_add_f32 v128, v128, v129
    s_waitcnt lgkmcnt(6)
    v_add_f32 v130, v130, v131
    v_add_f32 v130, v128, v130
    v_cvt_pk_bf16_f32 v128, v130, v130
    v_and_b32 v129, 0xffff0000, v128
    v_sub_f32 v129, v130, v129
    v_lshlrev_b32 v130, 16, v40
    v_cvt_pk_bf16_f32 v129, v129, v130
    v_cvt_pk_bf16_f32 v130, v130, 0
    v_mov_b32 v131, 0
    s_waitcnt lgkmcnt(4)
    v_add_f32 v132, v132, v133
    v_mfma_f32_32x32x16_bf16 v[96:111], v[248:251], v[144:147], v[96:111]
    s_add_u32 m0, s55, 0
    v_mfma_f32_16x16x32_bf16 v[28:31], v[248:251], v[24:27], v[28:31]
    ds_read_b64_tr_b16 v[240:241], v18 offset:32768
    ds_read_b64_tr_b16 v[242:243], v18 offset:33280
    buffer_load_dwordx4 v4, s[12:15], s56 offen lds
    s_waitcnt lgkmcnt(4)
    v_add_f32 v134, v134, v135
    v_add_f32 v134, v132, v134
    v_cvt_pk_bf16_f32 v132, v134, v134
    v_and_b32 v133, 0xffff0000, v132
    v_sub_f32 v133, v134, v133
    v_lshlrev_b32 v134, 16, v41
    v_cvt_pk_bf16_f32 v133, v133, v134
    v_cvt_pk_bf16_f32 v134, v134, 0
    v_mov_b32 v135, 0
    v_cvt_pk_bf16_f32 v49, v44, v44
    v_and_b32 v49, 0xffff0000, v49
    s_waitcnt lgkmcnt(2)
    v_mfma_f32_32x32x16_bf16 v[96:111], v[56:59], v[148:151], v[96:111]
    ds_read_b64_tr_b16 v[248:249], v19 offset:32768
    ds_read_b64_tr_b16 v[250:251], v19 offset:33280
    s_waitcnt vmcnt(3)
    s_barrier
    buffer_load_dwordx4 v10, s[12:15], s56 offen offset:1024 lds
    s_add_u32 s57, s100, 128
    s_sub_u32 s100, s100, 768
    s_min_u32 s100, s100, s57
    s_mul_i32 s56, s100, 1792
    v_sub_f32 v49, v44, v49
    v_cvt_pk_bf16_f32 v36, v44, v49
    v_cvt_pk_bf16_f32 v37, v44, v46
    v_and_b32 v49, 0xffff0000, v37
    v_sub_f32 v49, v46, v49
    v_cvt_pk_bf16_f32 v38, v49, 0
    v_cndmask_b32 v38, 0, v38, s[68:69]
    v_mov_b32 v39, 0
    v_cndmask_b32 v36, 0, v36, s[68:69]
    v_cndmask_b32 v37, 0, v37, s[68:69]
    v_mul_f32 v42, 0x3fb8aa3b, v45
    s_waitcnt lgkmcnt(2)
    v_mfma_f32_32x32x16_bf16 v[96:111], v[240:243], v[152:155], v[96:111]
    s_add_u32 m0, s55, 16384
    ds_read_b64_tr_b16 v[56:57], v16 offset:49152
    ds_read_b64_tr_b16 v[58:59], v16 offset:49664
    buffer_load_dwordx4 v4, s[12:15], s56 offen lds
    v_mfma_f32_32x32x16_bf16 v[64:79], v[128:131], v[36:39], v[64:79]
    v_add_u32 v44, 6144, v2
    v_add_u32 v45, 12288, v2
    v_add_u32 v46, 18432, v2
    s_waitcnt lgkmcnt(2)
    v_mfma_f32_32x32x16_bf16 v[96:111], v[248:251], v[156:159], v[96:111]
    ds_read_b64_tr_b16 v[240:241], v17 offset:49152
    ds_read_b64_tr_b16 v[242:243], v17 offset:49664
    buffer_load_dwordx4 v10, s[12:15], s56 offen offset:1024 lds
    s_add_u32 s57, s100, 128
    s_sub_u32 s100, s100, 768
    s_min_u32 s100, s100, s57
    s_mul_i32 s56, s100, 1792
    v_mfma_f32_32x32x16_bf16 v[80:95], v[132:135], v[36:39], v[80:95]
    buffer_load_ushort v40, v0, s[32:35], s63 offen
    buffer_load_ushort v41, v0, s[32:35], s64 offen
    s_waitcnt lgkmcnt(2)
    v_mfma_f32_32x32x16_bf16 v[96:111], v[56:59], v[160:163], v[96:111]
    s_add_u32 m0, s55, 32768
    v_mfma_f32_16x16x32_bf16 v[28:31], v[56:59], v[24:27], v[28:31]
    ds_read_b64_tr_b16 v[248:249], v18 offset:49152
    ds_read_b64_tr_b16 v[250:251], v18 offset:49664
    buffer_load_dwordx4 v4, s[12:15], s56 offen lds
    v_mul_f32 v64, v64, v42
    v_mul_f32 v65, v65, v42
    v_mul_f32 v66, v66, v42
    v_mul_f32 v67, v67, v42
    v_exp_f32 v52, v64
    v_exp_f32 v53, v65
    v_exp_f32 v54, v66
    v_exp_f32 v55, v67
    v_fma_f32 v52, v52, s75, s75
    v_fma_f32 v53, v53, s75, s75
    v_fma_f32 v54, v54, s75, s75
    v_fma_f32 v55, v55, s75, s75
    v_fma_f32 v52, v52, v52, 0.5
    v_fma_f32 v53, v53, v53, 0.5
    v_fma_f32 v54, v54, v54, 0.5
    v_fma_f32 v55, v55, v55, 0.5
    v_rcp_f32 v52, v52
    v_rcp_f32 v53, v53
    v_rcp_f32 v54, v54
    v_rcp_f32 v55, v55
    v_fma_f32 v52, -v64, v52, v64
    v_fma_f32 v53, -v65, v53, v65
    v_fma_f32 v54, -v66, v54, v66
    v_fma_f32 v55, -v67, v55, v67
    v_cvt_pk_bf16_f32 v64, v52, v53
    v_cvt_pk_bf16_f32 v65, v54, v55
    s_waitcnt lgkmcnt(2)
    v_mfma_f32_32x32x16_bf16 v[96:111], v[240:243], v[164:167], v[96:111]
    ds_read_b64_tr_b16 v[56:57], v19 offset:49152
    ds_read_b64_tr_b16 v[58:59], v19 offset:49664
    s_waitcnt vmcnt(7)
    s_barrier
    buffer_load_dwordx4 v10, s[12:15], s56 offen offset:1024 lds
    v_mul_f32 v68, v68, v42
    v_mul_f32 v69, v69, v42
    v_mul_f32 v70, v70, v42
    v_mul_f32 v71, v71, v42
    v_exp_f32 v52, v68
    v_exp_f32 v53, v69
    v_exp_f32 v54, v70
    v_exp_f32 v55, v71
    v_fma_f32 v52, v52, s75, s75
    v_fma_f32 v53, v53, s75, s75
    v_fma_f32 v54, v54, s75, s75
    v_fma_f32 v55, v55, s75, s75
    v_fma_f32 v52, v52, v52, 0.5
    v_fma_f32 v53, v53, v53, 0.5
    v_fma_f32 v54, v54, v54, 0.5
    v_fma_f32 v55, v55, v55, 0.5
    v_rcp_f32 v52, v52
    v_rcp_f32 v53, v53
    v_rcp_f32 v54, v54
    v_rcp_f32 v55, v55
    v_fma_f32 v52, -v68, v52, v68
    v_fma_f32 v53, -v69, v53, v69
    v_fma_f32 v54, -v70, v54, v70
    v_fma_f32 v55, -v71, v55, v71
    v_cvt_pk_bf16_f32 v66, v52, v53
    v_cvt_pk_bf16_f32 v67, v54, v55
    s_waitcnt lgkmcnt(2)
    v_mfma_f32_32x32x16_bf16 v[96:111], v[248:251], v[168:171], v[96:111]
    ds_read_b64_tr_b16 v[240:241], v16 offset:0
    ds_read_b64_tr_b16 v[242:243], v16 offset:512
    v_mul_f32 v72, v72, v42
    v_mul_f32 v73, v73, v42
    v_mul_f32 v74, v74, v42
    v_mul_f32 v75, v75, v42
    v_exp_f32 v52, v72
    v_exp_f32 v53, v73
    v_exp_f32 v54, v74
    v_exp_f32 v55, v75
    v_fma_f32 v52, v52, s75, s75
    v_fma_f32 v53, v53, s75, s75
    v_fma_f32 v54, v54, s75, s75
    v_fma_f32 v55, v55, s75, s75
    v_fma_f32 v52, v52, v52, 0.5
    v_fma_f32 v53, v53, v53, 0.5
    v_fma_f32 v54, v54, v54, 0.5
    v_fma_f32 v55, v55, v55, 0.5
    v_rcp_f32 v52, v52
    v_rcp_f32 v53, v53
    v_rcp_f32 v54, v54
    v_rcp_f32 v55, v55
    v_fma_f32 v52, -v72, v52, v72
    v_fma_f32 v53, -v73, v53, v73
    v_fma_f32 v54, -v74, v54, v74
    v_fma_f32 v55, -v75, v55, v75
    v_cvt_pk_bf16_f32 v68, v52, v53
    v_cvt_pk_bf16_f32 v69, v54, v55
    s_waitcnt lgkmcnt(2)
    v_mfma_f32_32x32x16_bf16 v[96:111], v[56:59], v[172:175], v[96:111]
    ds_read_b64_tr_b16 v[248:249], v17 offset:0
    ds_read_b64_tr_b16 v[250:251], v17 offset:512
    v_mul_f32 v76, v76, v42
    v_mul_f32 v77, v77, v42
    v_mul_f32 v78, v78, v42
    v_mul_f32 v79, v79, v42
    v_exp_f32 v52, v76
    v_exp_f32 v53, v77
    v_exp_f32 v54, v78
    v_exp_f32 v55, v79
    v_fma_f32 v52, v52, s75, s75
    v_fma_f32 v53, v53, s75, s75
    v_fma_f32 v54, v54, s75, s75
    v_fma_f32 v55, v55, s75, s75
    v_fma_f32 v52, v52, v52, 0.5
    v_fma_f32 v53, v53, v53, 0.5
    v_fma_f32 v54, v54, v54, 0.5
    v_fma_f32 v55, v55, v55, 0.5
    v_rcp_f32 v52, v52
    v_rcp_f32 v53, v53
    v_rcp_f32 v54, v54
    v_rcp_f32 v55, v55
    v_fma_f32 v52, -v76, v52, v76
    v_fma_f32 v53, -v77, v53, v77
    v_fma_f32 v54, -v78, v54, v78
    v_fma_f32 v55, -v79, v55, v79
    v_cvt_pk_bf16_f32 v70, v52, v53
    v_cvt_pk_bf16_f32 v71, v54, v55
    s_waitcnt lgkmcnt(2)
    v_mfma_f32_32x32x16_bf16 v[96:111], v[240:243], v[176:179], v[96:111]
    v_mfma_f32_16x16x32_bf16 v[28:31], v[240:243], v[24:27], v[28:31]
    ds_read_b64_tr_b16 v[56:57], v18 offset:0
    ds_read_b64_tr_b16 v[58:59], v18 offset:512
    v_subrev_u32 v16, 65536, v16
    buffer_store_dwordx4 v[64:67], v5, s[16:19], s71 offen offset:0 sc1
    buffer_store_dwordx4 v[68:71], v5, s[16:19], s71 offen offset:1024 sc1
    v_mul_f32 v80, v80, v42
    v_mul_f32 v81, v81, v42
    v_mul_f32 v82, v82, v42
    v_mul_f32 v83, v83, v42
    v_exp_f32 v52, v80
    v_exp_f32 v53, v81
    v_exp_f32 v54, v82
    v_exp_f32 v55, v83
    v_fma_f32 v52, v52, s75, s75
    v_fma_f32 v53, v53, s75, s75
    v_fma_f32 v54, v54, s75, s75
    v_fma_f32 v55, v55, s75, s75
    v_fma_f32 v52, v52, v52, 0.5
    v_fma_f32 v53, v53, v53, 0.5
    s_waitcnt lgkmcnt(2)
    v_mfma_f32_32x32x16_bf16 v[96:111], v[248:251], v[180:183], v[96:111]
    ds_read_b64_tr_b16 v[240:241], v19 offset:0
    ds_read_b64_tr_b16 v[242:243], v19 offset:512
    s_waitcnt vmcnt(8)
    s_barrier
    v_subrev_u32 v17, 65536, v17
    v_fma_f32 v54, v54, v54, 0.5
    v_fma_f32 v55, v55, v55, 0.5
    v_rcp_f32 v52, v52
    v_rcp_f32 v53, v53
    v_rcp_f32 v54, v54
    v_rcp_f32 v55, v55
    v_fma_f32 v52, -v80, v52, v80
    v_fma_f32 v53, -v81, v53, v81
    v_fma_f32 v54, -v82, v54, v82
    v_fma_f32 v55, -v83, v55, v83
    v_cvt_pk_bf16_f32 v80, v52, v53
    v_cvt_pk_bf16_f32 v81, v54, v55
    v_mul_f32 v84, v84, v42
    v_mul_f32 v85, v85, v42
    v_mul_f32 v86, v86, v42
    s_waitcnt lgkmcnt(2)
    v_mfma_f32_32x32x16_bf16 v[96:111], v[56:59], v[184:187], v[96:111]
    s_add_u32 m0, s76, 98304
    ds_read_b64_tr_b16 v[248:249], v16 offset:0
    ds_read_b64_tr_b16 v[250:251], v16 offset:512
    s_add_u32 s57, s3, 57344
    buffer_load_dwordx4 v2, s[24:27], s57 offen offset:0 lds
    v_subrev_u32 v18, 65536, v18
    v_mul_f32 v87, v87, v42
    v_exp_f32 v52, v84
    v_exp_f32 v53, v85
    v_exp_f32 v54, v86
    v_exp_f32 v55, v87
    v_fma_f32 v52, v52, s75, s75
    v_fma_f32 v53, v53, s75, s75
    v_fma_f32 v54, v54, s75, s75
    v_fma_f32 v55, v55, s75, s75
    v_fma_f32 v52, v52, v52, 0.5
    v_fma_f32 v53, v53, v53, 0.5
    v_fma_f32 v54, v54, v54, 0.5
    v_fma_f32 v55, v55, v55, 0.5
    v_rcp_f32 v52, v52
    v_rcp_f32 v53, v53
    s_waitcnt lgkmcnt(2)
    v_mfma_f32_32x32x16_bf16 v[96:111], v[240:243], v[188:191], v[96:111]
    ds_read_b64_tr_b16 v[56:57], v17 offset:0
    ds_read_b64_tr_b16 v[58:59], v17 offset:512
    buffer_load_dwordx4 v44, s[24:27], s57 offen offset:1024 lds
    v_subrev_u32 v19, 65536, v19
    v_rcp_f32 v54, v54
    v_rcp_f32 v55, v55
    v_fma_f32 v52, -v84, v52, v84
    v_fma_f32 v53, -v85, v53, v85
    v_fma_f32 v54, -v86, v54, v86
    v_fma_f32 v55, -v87, v55, v87
    v_cvt_pk_bf16_f32 v82, v52, v53
    v_cvt_pk_bf16_f32 v83, v54, v55
    v_mul_f32 v88, v88, v42
    v_mul_f32 v89, v89, v42
    v_mul_f32 v90, v90, v42
    v_mul_f32 v91, v91, v42
    v_exp_f32 v52, v88
    v_exp_f32 v53, v89
    v_exp_f32 v54, v90
    s_waitcnt lgkmcnt(2)
    v_mfma_f32_32x32x16_bf16 v[96:111], v[248:251], v[192:195], v[96:111]
    v_mfma_f32_16x16x32_bf16 v[28:31], v[248:251], v[24:27], v[28:31]
    ds_read_b64_tr_b16 v[240:241], v18 offset:0
    ds_read_b64_tr_b16 v[242:243], v18 offset:512
    buffer_load_dwordx4 v45, s[24:27], s57 offen offset:2048 lds
    v_exp_f32 v55, v91
    v_fma_f32 v52, v52, s75, s75
    v_fma_f32 v53, v53, s75, s75
    v_fma_f32 v54, v54, s75, s75
    v_fma_f32 v55, v55, s75, s75
    v_fma_f32 v52, v52, v52, 0.5
    v_fma_f32 v53, v53, v53, 0.5
    v_fma_f32 v54, v54, v54, 0.5
    v_fma_f32 v55, v55, v55, 0.5
    v_rcp_f32 v52, v52
    v_rcp_f32 v53, v53
    v_rcp_f32 v54, v54
    v_rcp_f32 v55, v55
    v_fma_f32 v52, -v88, v52, v88
    v_fma_f32 v53, -v89, v53, v89
    s_waitcnt lgkmcnt(2)
    v_mfma_f32_32x32x16_bf16 v[96:111], v[56:59], v[196:199], v[96:111]
    ds_read_b64_tr_b16 v[248:249], v19 offset:0
    ds_read_b64_tr_b16 v[250:251], v19 offset:512
    s_waitcnt vmcnt(9)
    s_barrier
    buffer_load_dwordx4 v46, s[24:27], s57 offen offset:3072 lds
    v_fma_f32 v54, -v90, v54, v90
    v_fma_f32 v55, -v91, v55, v91
    v_cvt_pk_bf16_f32 v84, v52, v53
    v_cvt_pk_bf16_f32 v85, v54, v55
    v_mul_f32 v92, v92, v42
    v_mul_f32 v93, v93, v42
    v_mul_f32 v94, v94, v42
    v_mul_f32 v95, v95, v42
    v_exp_f32 v52, v92
    v_exp_f32 v53, v93
    v_exp_f32 v54, v94
    v_exp_f32 v55, v95
    v_fma_f32 v52, v52, s75, s75
    v_fma_f32 v53, v53, s75, s75
    v_fma_f32 v54, v54, s75, s75
    s_waitcnt lgkmcnt(2)
    v_mfma_f32_32x32x16_bf16 v[96:111], v[240:243], v[200:203], v[96:111]
    s_add_u32 m0, s76, 65536
    ds_read_b64_tr_b16 v[56:57], v16 offset:16384
    ds_read_b64_tr_b16 v[58:59], v16 offset:16896
    s_add_u32 s57, s3, 229376
    buffer_load_dwordx4 v2, s[24:27], s57 offen offset:0 lds
    v_fma_f32 v55, v55, s75, s75
    v_fma_f32 v52, v52, v52, 0.5
    v_fma_f32 v53, v53, v53, 0.5
    v_fma_f32 v54, v54, v54, 0.5
    v_fma_f32 v55, v55, v55, 0.5
    v_rcp_f32 v52, v52
    v_rcp_f32 v53, v53
    v_rcp_f32 v54, v54
    v_rcp_f32 v55, v55
    v_fma_f32 v52, -v92, v52, v92
    v_fma_f32 v53, -v93, v53, v93
    v_fma_f32 v54, -v94, v54, v94
    v_fma_f32 v55, -v95, v55, v95
    v_cvt_pk_bf16_f32 v86, v52, v53
    v_cvt_pk_bf16_f32 v87, v54, v55
    s_waitcnt lgkmcnt(2)
    v_mfma_f32_32x32x16_bf16 v[96:111], v[248:251], v[204:207], v[96:111]
    ds_read_b64_tr_b16 v[240:241], v17 offset:16384
    ds_read_b64_tr_b16 v[242:243], v17 offset:16896
    buffer_load_dwordx4 v44, s[24:27], s57 offen offset:1024 lds
    buffer_store_dwordx4 v[80:83], v5, s[16:19], s72 offen offset:0 sc1
    buffer_store_dwordx4 v[84:87], v5, s[16:19], s72 offen offset:1024 sc1
    s_waitcnt lgkmcnt(2)
    v_mfma_f32_32x32x16_bf16 v[96:111], v[56:59], v[208:211], v[96:111]
    v_mfma_f32_16x16x32_bf16 v[28:31], v[56:59], v[24:27], v[28:31]
    ds_read_b64_tr_b16 v[248:249], v18 offset:16384
    ds_read_b64_tr_b16 v[250:251], v18 offset:16896
    buffer_load_dwordx4 v45, s[24:27], s57 offen offset:2048 lds
    s_waitcnt lgkmcnt(2)
    v_mfma_f32_32x32x16_bf16 v[96:111], v[240:243], v[212:215], v[96:111]
    ds_read_b64_tr_b16 v[56:57], v19 offset:16384
    ds_read_b64_tr_b16 v[58:59], v19 offset:16896
    s_waitcnt vmcnt(11)
    s_barrier
    buffer_load_dwordx4 v46, s[24:27], s57 offen offset:3072 lds
    s_waitcnt lgkmcnt(2)
    v_mfma_f32_32x32x16_bf16 v[96:111], v[248:251], v[216:219], v[96:111]
    ds_read_b64_tr_b16 v[240:241], v16 offset:32768
    ds_read_b64_tr_b16 v[242:243], v16 offset:33280
    s_waitcnt lgkmcnt(2)
    v_mfma_f32_32x32x16_bf16 v[96:111], v[56:59], v[220:223], v[96:111]
    ds_read_b64_tr_b16 v[248:249], v17 offset:32768
    ds_read_b64_tr_b16 v[250:251], v17 offset:33280
    s_waitcnt lgkmcnt(2)
    v_mfma_f32_32x32x16_bf16 v[96:111], v[240:243], v[224:227], v[96:111]
    v_mfma_f32_16x16x32_bf16 v[28:31], v[240:243], v[24:27], v[28:31]
    ds_read_b64_tr_b16 v[56:57], v18 offset:32768
    ds_read_b64_tr_b16 v[58:59], v18 offset:33280
    s_waitcnt lgkmcnt(2)
    v_mfma_f32_32x32x16_bf16 v[96:111], v[248:251], v[228:231], v[96:111]
    ds_read_b64_tr_b16 v[240:241], v19 offset:32768
    ds_read_b64_tr_b16 v[242:243], v19 offset:33280
    s_mov_b32 exec_lo, 0x00030003
    s_mov_b32 exec_hi, 0x00030003
    ds_write_b128 v43, v[28:31] offset:2048
    s_mov_b64 exec, -1
    s_waitcnt lgkmcnt(0)
    s_barrier
    v_and_b32 v48, 31, v1
    v_lshlrev_b32 v48, 2, v48
    s_lshl_b32 s58, s50, 10
    s_add_u32 s58, s58, 49152
    v_add_u32 v48, s58, v48
    ds_read_b32 v28, v48 offset:2048
    ds_read_b32 v29, v48 offset:2176
    ds_read_b32 v30, v48 offset:2304
    ds_read_b32 v31, v48 offset:2432
    v_mfma_f32_32x32x16_bf16 v[96:111], v[56:59], v[232:235], v[96:111]
    s_add_u32 m0, s76, 0
    s_add_u32 s57, s3, 286720
    buffer_load_dwordx4 v2, s[24:27], s57 offen offset:0 lds
    buffer_load_dwordx4 v44, s[24:27], s57 offen offset:1024 lds
    s_waitcnt lgkmcnt(2)
    v_add_f32 v28, v28, v29
    s_waitcnt lgkmcnt(0)
    v_add_f32 v30, v30, v31
    v_add_f32 v30, v28, v30
    v_cvt_pk_bf16_f32 v28, v30, v30
    v_and_b32 v29, 0xffff0000, v28
    v_mfma_f32_32x32x16_bf16 v[96:111], v[240:243], v[236:239], v[96:111]
    buffer_load_dwordx4 v45, s[24:27], s57 offen offset:2048 lds
    buffer_load_dwordx4 v46, s[24:27], s57 offen offset:3072 lds
    s_waitcnt vmcnt(6)
    s_mov_b64 exec, 1
    buffer_store_dwordx2 v[6:7], off, s[16:19], s101 offset:0 sc1
    s_mov_b64 exec, -1
    v_sub_f32 v29, v30, v29
    v_lshlrev_b32 v30, 16, v40
    v_cvt_pk_bf16_f32 v29, v29, v30
    v_cvt_pk_bf16_f32 v30, v30, 0
    v_mov_b32 v31, 0
    s_nop 1
    v_mfma_f32_32x32x16_bf16 v[96:111], v[28:31], v[36:39], v[96:111]
    v_mov_b32 v20, v42
    v_mov_b32 v21, v42
    v_mov_b32 v12, s75
    v_mov_b32 v13, s75
    v_mov_b32 v14, 0.5
    v_mov_b32 v15, 0.5
    s_barrier
    s_add_u32 s57, s3, 114688
    s_add_u32 m0, s76, 32768
    s_nop 0
    buffer_load_dwordx4 v2, s[24:27], s57 offen offset:0 lds
    buffer_load_dwordx4 v44, s[24:27], s57 offen offset:1024 lds
    buffer_load_dwordx4 v45, s[24:27], s57 offen offset:2048 lds
    buffer_load_dwordx4 v46, s[24:27], s57 offen offset:3072 lds
    v_pk_mul_f32 v[96:97], v[96:97], v[20:21]
    v_pk_mul_f32 v[98:99], v[98:99], v[20:21]
    v_pk_mul_f32 v[100:101], v[100:101], v[20:21]
    v_pk_mul_f32 v[102:103], v[102:103], v[20:21]
    v_exp_f32 v48, v96
    v_exp_f32 v49, v97
    v_exp_f32 v50, v98
    v_exp_f32 v51, v99
    v_exp_f32 v52, v100
    v_exp_f32 v53, v101
    v_exp_f32 v54, v102
    v_exp_f32 v55, v103
    v_pk_fma_f32 v[48:49], v[48:49], v[12:13], v[12:13]
    v_pk_fma_f32 v[50:51], v[50:51], v[12:13], v[12:13]
    v_pk_fma_f32 v[52:53], v[52:53], v[12:13], v[12:13]
    v_pk_fma_f32 v[54:55], v[54:55], v[12:13], v[12:13]
    v_pk_fma_f32 v[48:49], v[48:49], v[48:49], v[14:15]
    v_pk_fma_f32 v[50:51], v[50:51], v[50:51], v[14:15]
    v_pk_fma_f32 v[52:53], v[52:53], v[52:53], v[14:15]
    v_pk_fma_f32 v[54:55], v[54:55], v[54:55], v[14:15]
    v_rcp_f32 v48, v48
    v_rcp_f32 v49, v49
    v_rcp_f32 v50, v50
    v_rcp_f32 v51, v51
    v_rcp_f32 v52, v52
    v_rcp_f32 v53, v53
    v_rcp_f32 v54, v54
    v_rcp_f32 v55, v55
    v_pk_fma_f32 v[48:49], v[96:97], v[48:49], v[96:97] neg_lo:[1,0,0] neg_hi:[1,0,0]
    v_pk_fma_f32 v[50:51], v[98:99], v[50:51], v[98:99] neg_lo:[1,0,0] neg_hi:[1,0,0]
    v_pk_fma_f32 v[52:53], v[100:101], v[52:53], v[100:101] neg_lo:[1,0,0] neg_hi:[1,0,0]
    v_pk_fma_f32 v[54:55], v[102:103], v[54:55], v[102:103] neg_lo:[1,0,0] neg_hi:[1,0,0]
    v_cvt_pk_bf16_f32 v96, v48, v49
    v_cvt_pk_bf16_f32 v97, v50, v51
    v_cvt_pk_bf16_f32 v98, v52, v53
    v_cvt_pk_bf16_f32 v99, v54, v55
    v_pk_mul_f32 v[104:105], v[104:105], v[20:21]
    v_pk_mul_f32 v[106:107], v[106:107], v[20:21]
    v_pk_mul_f32 v[108:109], v[108:109], v[20:21]
    v_pk_mul_f32 v[110:111], v[110:111], v[20:21]
    v_exp_f32 v48, v104
    v_exp_f32 v49, v105
    v_exp_f32 v50, v106
    v_exp_f32 v51, v107
    v_exp_f32 v52, v108
    v_exp_f32 v53, v109
    v_exp_f32 v54, v110
    v_exp_f32 v55, v111
    v_pk_fma_f32 v[48:49], v[48:49], v[12:13], v[12:13]
    v_pk_fma_f32 v[50:51], v[50:51], v[12:13], v[12:13]
    v_pk_fma_f32 v[52:53], v[52:53], v[12:13], v[12:13]
    v_pk_fma_f32 v[54:55], v[54:55], v[12:13], v[12:13]
    v_pk_fma_f32 v[48:49], v[48:49], v[48:49], v[14:15]
    v_pk_fma_f32 v[50:51], v[50:51], v[50:51], v[14:15]
    v_pk_fma_f32 v[52:53], v[52:53], v[52:53], v[14:15]
    v_pk_fma_f32 v[54:55], v[54:55], v[54:55], v[14:15]
    v_rcp_f32 v48, v48
    v_rcp_f32 v49, v49
    v_rcp_f32 v50, v50
    v_rcp_f32 v51, v51
    v_rcp_f32 v52, v52
    v_rcp_f32 v53, v53
    v_rcp_f32 v54, v54
    v_rcp_f32 v55, v55
    v_pk_fma_f32 v[48:49], v[104:105], v[48:49], v[104:105] neg_lo:[1,0,0] neg_hi:[1,0,0]
    v_pk_fma_f32 v[50:51], v[106:107], v[50:51], v[106:107] neg_lo:[1,0,0] neg_hi:[1,0,0]
    v_pk_fma_f32 v[52:53], v[108:109], v[52:53], v[108:109] neg_lo:[1,0,0] neg_hi:[1,0,0]
    v_pk_fma_f32 v[54:55], v[110:111], v[54:55], v[110:111] neg_lo:[1,0,0] neg_hi:[1,0,0]
    v_cvt_pk_bf16_f32 v100, v48, v49
    v_cvt_pk_bf16_f32 v101, v50, v51
    v_cvt_pk_bf16_f32 v102, v52, v53
    v_cvt_pk_bf16_f32 v103, v54, v55
    buffer_store_dwordx4 v[96:99], v5, s[16:19], s73 offen offset:0 sc1
    buffer_store_dwordx4 v[100:103], v5, s[16:19], s73 offen offset:1024 sc1
    buffer_load_dwordx2 v[10:11], v9, s[16:19], s77 offen offset:0 sc1
    v_lshrrev_b32 v48, 5, v1
    v_bfe_u32 v49, v1, 2, 2
    v_lshl_add_u32 v48, v48, 2, v49
    v_lshlrev_b32 v48, 7, v48
    v_bfe_u32 v50, v1, 4, 1
    v_lshlrev_b32 v50, 5, v50
    v_and_b32 v51, 3, v1
    v_lshl_add_u32 v50, v51, 3, v50
    v_lshrrev_b32 v49, 1, v49
    v_lshlrev_b32 v49, 6, v49
    v_xor_b32 v50, v50, v49
    v_add_u32 v48, v48, v50
    v_add_u32 v12, s76, v48
    v_and_b32 v12, 0xffffefff, v12
    v_xor_b32 v13, 64, v12
    v_add_u32 v14, 0x10000, v12
    v_add_u32 v15, 0x10000, v13
    v_add_u32 v16, 0x20000, v12
    v_add_u32 v17, 0x20000, v13
    v_and_b32 v48, 31, v1
    v_mul_u32_u24 v48, 896, v48
    v_lshrrev_b32 v49, 5, v1
    v_lshl_add_u32 v18, v49, 4, v48
    buffer_load_dwordx4 v[20:23], v18, s[8:11], s7 offen
    s_mov_b32 s75, 0x3f317218
    s_waitcnt vmcnt(2)
    s_mov_b64 exec, 1
    buffer_store_dwordx2 v[6:7], off, s[16:19], s101 offset:128 sc1
    s_mov_b64 exec, -1
    s_waitcnt vmcnt(2)
    v_cmp_ne_u64 s[82:83], v[6:7], v[10:11]
    s_nop 0
    s_cmp_eq_u64 s[82:83], 0
    s_cbranch_scc0 L_ps_10
L_pb_11:
    s_add_u32 s57, s5, 0
    buffer_load_dwordx4 v[128:131], v5, s[16:19], s57 offen offset:0 sc1
    buffer_load_dwordx4 v[132:135], v5, s[16:19], s57 offen offset:1024 sc1
    buffer_load_dwordx4 v[136:139], v5, s[16:19], s57 offen offset:2048 sc1
    buffer_load_dwordx4 v[140:143], v5, s[16:19], s57 offen offset:3072 sc1
    s_add_u32 s57, s5, 4096
    buffer_load_dwordx4 v[144:147], v5, s[16:19], s57 offen offset:0 sc1
    buffer_load_dwordx4 v[148:151], v5, s[16:19], s57 offen offset:1024 sc1
    buffer_load_dwordx4 v[152:155], v5, s[16:19], s57 offen offset:2048 sc1
    buffer_load_dwordx4 v[156:159], v5, s[16:19], s57 offen offset:3072 sc1
    s_add_u32 s57, s5, 16384
    buffer_load_dwordx4 v[160:163], v5, s[16:19], s57 offen offset:0 sc1
    buffer_load_dwordx4 v[164:167], v5, s[16:19], s57 offen offset:1024 sc1
    buffer_load_dwordx4 v[168:171], v5, s[16:19], s57 offen offset:2048 sc1
    buffer_load_dwordx4 v[172:175], v5, s[16:19], s57 offen offset:3072 sc1
    s_add_u32 s57, s5, 20480
    buffer_load_dwordx4 v[176:179], v5, s[16:19], s57 offen offset:0 sc1
    buffer_load_dwordx4 v[180:183], v5, s[16:19], s57 offen offset:1024 sc1
    buffer_load_dwordx4 v[184:187], v5, s[16:19], s57 offen offset:2048 sc1
    buffer_load_dwordx4 v[188:191], v5, s[16:19], s57 offen offset:3072 sc1
    s_nop 1
    s_branch L_ph2
    s_nop 0
L_attn:
    s_load_dwordx2 s[44:45], s[0:1], 8
    s_load_dwordx2 s[16:17], s[0:1], 80
    s_load_dwordx2 s[36:37], s[0:1], 16
    s_load_dwordx2 s[28:29], s[0:1], 24
    s_load_dwordx2 s[24:25], s[0:1], 56
    s_load_dwordx2 s[20:21], s[0:1], 64
    v_lshrrev_b32 v2, 6, v0
    v_and_b32 v1, 63, v0
    s_and_b32 s78, s2, 7
    v_readfirstlane_b32 s48, v2
    s_lshr_b32 s79, s2, 3
    s_mov_b32 s68, -1
    s_mov_b32 s69, 0
    v_lshlrev_b32 v5, 4, v1
    s_mov_b32 s10, 1835008
    s_mov_b32 s11, 0x20000
    s_mov_b32 s46, 1204224
    s_mov_b32 s47, 0x20000
    s_mov_b32 s42, 256
    s_mov_b32 s43, 0x20000
    s_mov_b32 s38, 25088
    s_mov_b32 s39, 0x20000
    s_mov_b32 s18, 268435456
    s_mov_b32 s19, 0x20000
    s_mov_b32 s30, 401408
    s_mov_b32 s31, 0x20000
    s_mov_b32 s26, 1605632
    s_mov_b32 s27, 0x20000
    s_mov_b32 s22, 1835008
    s_mov_b32 s23, 0x20000
    s_and_b32 s57, s78, 1
    s_lshl_b32 s57, s57, 2
    s_and_b32 s58, s79, 3
    s_add_u32 s51, s57, s58
    s_lshr_b32 s57, s78, 1
    s_lshl_b32 s57, s57, 2
    s_lshr_b32 s58, s79, 2
    s_add_u32 s57, s57, s58
    s_lshl_b32 s57, s57, 2
    s_mov_b32 s82, 0x64752310
    s_mov_b32 s83, 0xdfecb9a8
    s_lshr_b64 s[82:83], s[82:83], s57
    s_and_b32 s52, s82, 15
    s_lshl_b32 s57, s51, 3
    s_add_u32 s57, s57, s48
    s_mul_i32 s54, s57, 28672
    s_lshl_b32 s71, s57, 5
    s_lshr_b32 s50, s48, 2
    s_and_b32 s53, s48, 3
    s_lshl_b32 s76, s53, 13
    s_lshl_b32 s58, s50, 12
    s_add_u32 s76, s76, s58
    s_lshl_b32 s58, s50, 15
    s_lshl_b32 s59, s53, 10
    s_add_u32 s56, s58, s59
    s_mul_i32 s57, s52, 56
    s_cmp_eq_u32 s52, 15
    s_cselect_b32 s72, 8, 0
    s_sub_u32 s62, s57, s72
    s_mul_i32 s58, s50, 896
    s_add_u32 s58, s58, 896
    s_add_u32 s61, s62, s58
    s_mul_i32 s58, s53, 43008
    s_add_u32 s61, s61, s58
    s_mov_b32 s82, 0x16426420
    s_mov_b32 s83, 0x53163164
    s_lshl_b32 s57, s79, 2
    s_lshr_b64 s[82:83], s[82:83], s57
    s_and_b32 s57, s82, 15
    s_lshl_b32 s100, s57, 7
    v_lshrrev_b32 v48, 3, v1
    v_lshrrev_b32 v49, 4, v1
    v_and_b32 v50, 7, v1
    v_mul_u32_u24 v51, 896, v48
    v_xor_b32 v52, v50, v49
    v_lshl_add_u32 v2, v52, 4, v51
    v_xor_b32 v52, 4, v52
    v_lshl_add_u32 v3, v52, 4, v51
    v_add_u32 v3, 7168, v3
    v_lshrrev_b32 v48, 2, v1
    v_mul_u32_u24 v48, 2688, v48
    v_and_b32 v49, 3, v1
    v_lshl_add_u32 v4, v49, 4, v48
    s_waitcnt lgkmcnt(0)
    s_or_b32 s57, s2, s48
    s_cmp_lg_u32 s57, 0
    s_nop 1
    s_cbranch_scc1 L_nn_13
    s_memrealtime s[66:67]
    s_waitcnt lgkmcnt(0)
    s_or_b32 s57, s66, 1
    s_mul_i32 s58, s57, 0x9e3779b1
    s_mul_i32 s57, s57, 0x85ebca6b
    s_xor_b32 s57, s57, s67
    s_lshr_b32 s59, s58, 15
    s_xor_b32 s57, s57, s59
    v_mov_b32 v54, s58
    v_mov_b32 v55, s57
    s_mov_b64 exec, 1
    buffer_store_dwordx2 v[54:55], off, s[40:43], 0 sc1
    s_mov_b64 exec, -1
    s_nop 1
L_nn_13:
    s_mov_b32 s57, s100
    s_add_u32 s57, s57, s54
    s_add_u32 m0, s76, 65536
    s_nop 0
    buffer_load_dwordx4 v2, s[8:11], s57 offen lds
    s_mov_b32 s57, s100
    s_add_u32 s57, s57, s54
    s_add_u32 m0, s76, 66560
    s_nop 0
    buffer_load_dwordx4 v3, s[8:11], s57 offen lds
    s_mov_b32 s57, s100
    s_add_u32 s57, s57, s54
    s_add_u32 s57, s57, 14336
    s_add_u32 m0, s76, 67584
    s_nop 0
    buffer_load_dwordx4 v2, s[8:11], s57 offen lds
    s_mov_b32 s57, s100
    s_add_u32 s57, s57, s54
    s_add_u32 s57, s57, 14336
    s_add_u32 m0, s76, 68608
    s_nop 0
    buffer_load_dwordx4 v3, s[8:11], s57 offen lds
    s_mov_b32 s57, s100
    s_mul_i32 s57, s57, 1344
    s_add_u32 s57, s57, s61
    s_add_u32 m0, s56, 0
    s_nop 0
    buffer_load_dwordx4 v4, s[44:47], s57 offen lds
    s_add_u32 s57, s100, 128
    s_add_u32 s58, s100, 0xfffffd00
    s_min_u32 s57, s57, s58
    s_mul_i32 s57, s57, 1344
    s_add_u32 s57, s57, s61
    s_add_u32 m0, s56, 4096
    s_nop 0
    buffer_load_dwordx4 v4, s[44:47], s57 offen lds
    v_lshrrev_b32 v48, 4, v0
    v_and_b32 v49, 15, v0
    v_mul_u32_u24 v50, 56, v48
    v_lshl_add_u32 v50, v49, 2, v50
    v_add_u32 v51, 2, v49
    v_lshrrev_b32 v51, 3, v51
    v_lshrrev_b32 v52, 3, v49
    v_add_u32 v51, v51, v52
    v_lshlrev_b32 v51, 1, v51
    v_sub_u32 v50, v50, v51
    v_mov_b32 v51, 2147483632
    v_cmp_gt_u32 vcc, 28, v48
    s_nop 1
    v_cndmask_b32 v50, v51, v50, vcc
    v_and_b32 v52, 5, v49
    v_add_u32 v53, 2, v50
    v_cmp_ne_u32 vcc, 5, v52
    s_nop 1
    v_cndmask_b32 v53, v51, v53, vcc
    s_mul_i32 s57, s52, 1568
    buffer_load_ushort v126, v50, s[36:39], s57 offen
    buffer_load_ushort v127, v53, s[36:39], s57 offen
    v_lshlrev_b32 v0, 2, v0
    v_add_u32 v0, 61440, v0
    v_and_b32 v48, 31, v1
    v_lshrrev_b32 v49, 5, v1
    v_lshrrev_b32 v51, 1, v48
    v_and_b32 v51, 7, v51
    v_lshlrev_b32 v50, 7, v48
    v_add_u32 v50, s76, v50
    v_add_u32 v50, 65536, v50
    s_add_u32 s57, s53, 0
    s_and_b32 s57, s57, 3
    s_lshl_b32 s58, s57, 1
    v_add_u32 v52, s58, v49
    v_xor_b32 v52, v52, v51
    v_lshl_add_u32 v12, v52, 4, v50
    v_add_u32 v16, 0x10000, v12
    s_add_u32 s57, s53, 1
    s_and_b32 s57, s57, 3
    s_lshl_b32 s58, s57, 1
    v_add_u32 v52, s58, v49
    v_xor_b32 v52, v52, v51
    v_lshl_add_u32 v13, v52, 4, v50
    v_add_u32 v17, 0x10000, v13
    s_add_u32 s57, s53, 2
    s_and_b32 s57, s57, 3
    s_lshl_b32 s58, s57, 1
    v_add_u32 v52, s58, v49
    v_xor_b32 v52, v52, v51
    v_lshl_add_u32 v14, v52, 4, v50
    v_add_u32 v18, 0x10000, v14
    s_add_u32 s57, s53, 3
    s_and_b32 s57, s57, 3
    s_lshl_b32 s58, s57, 1
    v_add_u32 v52, s58, v49
    v_xor_b32 v52, v52, v51
    v_lshl_add_u32 v15, v52, 4, v50
    v_add_u32 v19, 0x10000, v15
    v_lshrrev_b32 v48, 5, v1
    v_lshlrev_b32 v48, 3, v48
    v_bfe_u32 v49, v1, 2, 2
    v_add_u32 v48, v48, v49
    v_lshlrev_b32 v48, 6, v48
    v_bfe_u32 v49, v1, 4, 1
    v_lshlrev_b32 v49, 5, v49
    v_and_b32 v50, 3, v1
    v_lshl_add_u32 v49, v50, 3, v49
    v_add_u32 v48, v48, v49
    v_add_u32 v48, s72, v48
    s_add_u32 s57, s53, 0
    s_and_b32 s57, s57, 3
    s_lshl_b32 s57, s57, 10
    v_add_u32 v20, s57, v48
    s_add_u32 s57, s53, 1
    s_and_b32 s57, s57, 3
    s_lshl_b32 s57, s57, 10
    v_add_u32 v21, s57, v48
    s_add_u32 s57, s53, 2
    s_and_b32 s57, s57, 3
    s_lshl_b32 s57, s57, 10
    v_add_u32 v22, s57, v48
    s_add_u32 s57, s53, 3
    s_and_b32 s57, s57, 3
    s_lshl_b32 s57, s57, 10
    v_add_u32 v23, s57, v48
    s_lshl_b32 s57, s48, 7
    s_add_u32 s57, s57, 63488
    v_and_b32 v43, 1, v1
    v_lshlrev_b32 v43, 6, v43
    v_lshrrev_b32 v48, 4, v1
    v_lshl_add_u32 v43, v48, 4, v43
    v_add_u32 v43, s57, v43
    s_mov_b32 s82, 0x00020001
    s_mov_b32 s83, 0x00020001
    v_mov_b32 v25, 0x3f803f80
    v_cndmask_b32 v24, 0, v25, s[82:83]
    v_mov_b32 v25, v24
    v_mov_b32 v26, v24
    v_mov_b32 v27, v24
    s_add_u32 s57, s48, 0
    s_lshl_b32 s57, s57, 7
    s_add_u32 s57, s57, s100
    s_sub_u32 s58, s57, 896
    s_min_u32 s57, s57, s58
    s_mul_i32 s57, s57, 1344
    s_add_u32 s57, s57, s62
    s_cmp_eq_u32 s48, 7
    s_cselect_b32 s73, 2147483632, s57
    s_add_u32 s60, s79, 16
    s_min_u32 s60, s60, 27
    s_mul_i32 s57, s60, 9363
    s_lshr_b32 s57, s57, 16
    s_mul_i32 s58, s57, 7
    s_sub_u32 s81, s60, s58
    s_and_b32 s58, s2, 7
    s_lshl2_add_u32 s80, s58, s57
    s_and_b32 s57, s48, 3
    s_lshr_b32 s58, s48, 2
    s_lshl_b32 s59, s81, 7
    s_mul_i32 s3, s57, 401408
    s_mul_i32 s76, s58, 28672
    s_add_u32 s3, s3, s76
    s_add_u32 s3, s3, s59
    s_mul_i32 s4, s57, 100352
    s_mul_i32 s76, s58, 25088
    s_add_u32 s4, s4, s76
    s_add_u32 s4, s4, s59
    s_lshl_b32 s77, s80, 1
    s_add_u32 s77, s77, s58
    s_mul_i32 s7, s77, 28672
    s_add_u32 s7, s7, s59
    s_lshl_b32 s76, s57, 5
    s_add_u32 s7, s7, s76
    s_mul_i32 s6, s77, 147456
    s_mul_i32 s76, s57, 28672
    s_add_u32 s5, s6, s76
    s_lshl_b32 s76, s57, 13
    s_add_u32 s6, s6, s76
    s_add_u32 s6, s6, 114688
    s_lshl_b32 s77, s77, 8
    s_lshl_b32 s59, s57, 5
    s_add_u32 s77, s77, s59
    s_add_u32 s77, s77, 12582912
    s_lshl_b32 s58, s58, 12
    s_add_u32 s76, s76, s58
    s_cmp_ge_u32 s79, 12
    s_cselect_b32 s3, 2147483632, s3
    s_cselect_b32 s4, 2147483632, s4
    s_cselect_b32 s5, 2147483632, s5
    s_add_u32 s57, s100, 128
    s_add_u32 s58, s100, 0xfffffd00
    s_min_u32 s57, s57, s58
    s_add_u32 s57, s57, s54
    s_add_u32 m0, s76, 131072
    s_nop 0
    buffer_load_dwordx4 v2, s[8:11], s57 offen lds
    s_add_u32 s57, s100, 128
    s_add_u32 s58, s100, 0xfffffd00
    s_min_u32 s57, s57, s58
    s_add_u32 s57, s57, s54
    s_add_u32 m0, s76, 132096
    s_nop 0
    buffer_load_dwordx4 v3, s[8:11], s57 offen lds
    s_add_u32 s57, s100, 128
    s_add_u32 s58, s100, 0xfffffd00
    s_min_u32 s57, s57, s58
    s_add_u32 s57, s57, s54
    s_add_u32 s57, s57, 14336
    s_add_u32 m0, s76, 133120
    s_nop 0
    buffer_load_dwordx4 v2, s[8:11], s57 offen lds
    s_add_u32 s57, s100, 128
    s_add_u32 s58, s100, 0xfffffd00
    s_min_u32 s57, s57, s58
    s_add_u32 s57, s57, s54
    s_add_u32 s57, s57, 14336
    s_add_u32 m0, s76, 134144
    s_nop 0
    buffer_load_dwordx4 v3, s[8:11], s57 offen lds
    s_add_u32 s57, s100, 256
    s_add_u32 s58, s100, 0xfffffd80
    s_min_u32 s57, s57, s58
    s_mul_i32 s57, s57, 1344
    s_add_u32 s57, s57, s61
    s_add_u32 m0, s56, 8192
    s_nop 0
    buffer_load_dwordx4 v4, s[44:47], s57 offen lds
    s_add_u32 s57, s100, 384
    s_add_u32 s58, s100, 0xfffffe00
    s_min_u32 s57, s57, s58
    s_mul_i32 s57, s57, 1344
    s_add_u32 s57, s57, s61
    s_add_u32 m0, s56, 12288
    s_nop 0
    buffer_load_dwordx4 v4, s[44:47], s57 offen lds
    s_waitcnt vmcnt(8)
    s_barrier
    ds_read_b128 v[128:131], v12 offset:0
    ds_read_b64_tr_b16 v[56:57], v20 offset:0
    ds_read_b64_tr_b16 v[58:59], v20 offset:256
    ds_read_b64_tr_b16 v[60:61], v20 offset:32768
    ds_read_b64_tr_b16 v[62:63], v20 offset:33024
    ds_read_b128 v[132:135], v13 offset:0
    ds_read_b128 v[136:139], v14 offset:0
    ds_read_b64_tr_b16 v[240:241], v21 offset:0
    ds_read_b64_tr_b16 v[242:243], v21 offset:256
    ds_read_b64_tr_b16 v[244:245], v21 offset:32768
    ds_read_b64_tr_b16 v[246:247], v21 offset:33024
    ds_read_b128 v[140:143], v15 offset:0
    s_waitcnt lgkmcnt(9)
    v_mfma_f32_32x32x16_bf16 v[64:79], v[56:59], v[128:131], 0
    v_mfma_f32_16x16x32_bf16 v[28:31], v[56:59], v[24:27], 0
    ds_read_b64_tr_b16 v[248:249], v22 offset:0
    ds_read_b64_tr_b16 v[250:251], v22 offset:256
    s_add_u32 s57, s100, 256
    s_add_u32 s58, s100, 0xfffffd80
    s_min_u32 s57, s57, s58
    s_add_u32 s57, s57, s54
    s_add_u32 m0, s76, 98304
    s_nop 0
    buffer_load_dwordx4 v2, s[8:11], s57 offen lds
    s_waitcnt lgkmcnt(9)
    v_mfma_f32_32x32x16_bf16 v[80:95], v[60:63], v[128:131], 0
    v_mfma_f32_16x16x32_bf16 v[32:35], v[60:63], v[24:27], 0
    ds_read_b64_tr_b16 v[252:253], v22 offset:32768
    ds_read_b64_tr_b16 v[254:255], v22 offset:33024
    s_add_u32 s57, s100, 256
    s_add_u32 s58, s100, 0xfffffd80
    s_min_u32 s57, s57, s58
    s_add_u32 s57, s57, s54
    s_add_u32 m0, s76, 99328
    s_nop 0
    buffer_load_dwordx4 v3, s[8:11], s57 offen lds
    s_waitcnt lgkmcnt(7)
    v_mfma_f32_32x32x16_bf16 v[64:79], v[240:243], v[132:135], v[64:79]
    ds_read_b64_tr_b16 v[56:57], v23 offset:0
    ds_read_b64_tr_b16 v[58:59], v23 offset:256
    s_add_u32 s57, s100, 256
    s_add_u32 s58, s100, 0xfffffd80
    s_min_u32 s57, s57, s58
    s_add_u32 s57, s57, s54
    s_add_u32 s57, s57, 14336
    s_add_u32 m0, s76, 100352
    s_nop 0
    buffer_load_dwordx4 v2, s[8:11], s57 offen lds
    s_waitcnt lgkmcnt(7)
    v_mfma_f32_32x32x16_bf16 v[80:95], v[244:247], v[132:135], v[80:95]
    ds_read_b64_tr_b16 v[60:61], v23 offset:32768
    ds_read_b64_tr_b16 v[62:63], v23 offset:33024
    s_add_u32 s57, s100, 256
    s_add_u32 s58, s100, 0xfffffd80
    s_min_u32 s57, s57, s58
    s_add_u32 s57, s57, s54
    s_add_u32 s57, s57, 14336
    s_add_u32 m0, s76, 101376
    s_nop 0
    buffer_load_dwordx4 v3, s[8:11], s57 offen lds
    s_waitcnt lgkmcnt(6)
    v_mfma_f32_32x32x16_bf16 v[64:79], v[248:251], v[136:139], v[64:79]
    s_waitcnt vmcnt(6)
    ds_read_b128 v[144:147], v16 offset:0
    ds_read_b64_tr_b16 v[240:241], v20 offset:4096
    ds_read_b64_tr_b16 v[242:243], v20 offset:4352
    s_add_u32 s57, s100, 384
    s_add_u32 s58, s100, 0xfffffe00
    s_min_u32 s57, s57, s58
    s_add_u32 s57, s57, s54
    s_add_u32 m0, s76, 65536
    s_nop 0
    buffer_load_dwordx4 v2, s[8:11], s57 offen lds
    buffer_load_dwordx2 v[6:7], off, s[40:43], 0 sc1
    s_waitcnt lgkmcnt(7)
    v_mfma_f32_32x32x16_bf16 v[80:95], v[252:255], v[136:139], v[80:95]
    ds_read_b64_tr_b16 v[244:245], v20 offset:36864
    ds_read_b64_tr_b16 v[246:247], v20 offset:37120
    ds_read_b128 v[148:151], v17 offset:0
    s_add_u32 s57, s100, 384
    s_add_u32 s58, s100, 0xfffffe00
    s_min_u32 s57, s57, s58
    s_add_u32 s57, s57, s54
    s_add_u32 m0, s76, 66560
    s_nop 0
    buffer_load_dwordx4 v3, s[8:11], s57 offen lds
    s_waitcnt lgkmcnt(8)
    v_mfma_f32_32x32x16_bf16 v[64:79], v[56:59], v[140:143], v[64:79]
    ds_read_b128 v[152:155], v18 offset:0
    ds_read_b64_tr_b16 v[248:249], v21 offset:4096
    ds_read_b64_tr_b16 v[250:251], v21 offset:4352
    s_add_u32 s57, s100, 384
    s_add_u32 s58, s100, 0xfffffe00
    s_min_u32 s57, s57, s58
    s_add_u32 s57, s57, s54
    s_add_u32 s57, s57, 14336
    s_add_u32 m0, s76, 67584
    s_nop 0
    buffer_load_dwordx4 v2, s[8:11], s57 offen lds
    s_waitcnt lgkmcnt(9)
    v_mfma_f32_32x32x16_bf16 v[80:95], v[60:63], v[140:143], v[80:95]
    ds_read_b64_tr_b16 v[252:253], v21 offset:36864
    ds_read_b64_tr_b16 v[254:255], v21 offset:37120
    ds_read_b128 v[156:159], v19 offset:0
    s_add_u32 s57, s100, 384
    s_add_u32 s58, s100, 0xfffffe00
    s_min_u32 s57, s57, s58
    s_add_u32 s57, s57, s54
    s_add_u32 s57, s57, 14336
    s_add_u32 m0, s76, 68608
    s_nop 0
    buffer_load_dwordx4 v3, s[8:11], s57 offen lds
    s_waitcnt lgkmcnt(9)
    v_mfma_f32_32x32x16_bf16 v[64:79], v[240:243], v[144:147], v[64:79]
    v_mfma_f32_16x16x32_bf16 v[28:31], v[240:243], v[24:27], v[28:31]
    ds_read_b64_tr_b16 v[56:57], v22 offset:4096
    ds_read_b64_tr_b16 v[58:59], v22 offset:4352
    s_add_u32 s57, s100, 512
    s_add_u32 s58, s100, 0xfffffe80
    s_min_u32 s57, s57, s58
    s_mul_i32 s57, s57, 1344
    s_add_u32 s57, s57, s61
    s_add_u32 m0, s56, 16384
    s_nop 0
    buffer_load_dwordx4 v4, s[44:47], s57 offen lds
    s_waitcnt lgkmcnt(9)
    v_mfma_f32_32x32x16_bf16 v[80:95], v[244:247], v[144:147], v[80:95]
    v_mfma_f32_16x16x32_bf16 v[32:35], v[244:247], v[24:27], v[32:35]
    ds_read_b64_tr_b16 v[60:61], v22 offset:36864
    ds_read_b64_tr_b16 v[62:63], v22 offset:37120
    s_add_u32 s57, s100, 640
    s_add_u32 s58, s100, 0xffffff00
    s_min_u32 s57, s57, s58
    s_mul_i32 s57, s57, 1344
    s_add_u32 s57, s57, s61
    s_add_u32 m0, s56, 20480
    s_nop 0
    buffer_load_dwordx4 v4, s[44:47], s57 offen lds
    s_waitcnt lgkmcnt(7)
    v_mfma_f32_32x32x16_bf16 v[64:79], v[248:251], v[148:151], v[64:79]
    ds_read_b64_tr_b16 v[240:241], v23 offset:4096
    ds_read_b64_tr_b16 v[242:243], v23 offset:4352
    s_add_u32 s57, s100, 768
    s_add_u32 s58, s100, 0xffffff80
    s_min_u32 s57, s57, s58
    s_mul_i32 s57, s57, 1344
    s_add_u32 s57, s57, s61
    s_add_u32 m0, s56, 24576
    s_nop 0
    buffer_load_dwordx4 v4, s[44:47], s57 offen lds
    s_waitcnt lgkmcnt(7)
    v_mfma_f32_32x32x16_bf16 v[80:95], v[252:255], v[148:151], v[80:95]
    s_waitcnt vmcnt(12)
    s_barrier
    ds_read_b64_tr_b16 v[244:245], v23 offset:36864
    ds_read_b64_tr_b16 v[246:247], v23 offset:37120
    s_waitcnt lgkmcnt(6)
    v_mfma_f32_32x32x16_bf16 v[64:79], v[56:59], v[152:155], v[64:79]
    s_waitcnt vmcnt(8)
    ds_read_b128 v[160:163], v12 offset:32768
    ds_read_b64_tr_b16 v[248:249], v20 offset:8192
    ds_read_b64_tr_b16 v[250:251], v20 offset:8448
    s_add_u32 s57, s100, 512
    s_add_u32 s58, s100, 0xfffffe80
    s_min_u32 s57, s57, s58
    s_add_u32 s57, s57, s54
    s_add_u32 m0, s76, 131072
    s_nop 0
    buffer_load_dwordx4 v2, s[8:11], s57 offen lds
    v_lshl_or_b32 v126, v127, 16, v126
    ds_write_b32 v0, v126
    s_waitcnt lgkmcnt(8)
    v_mfma_f32_32x32x16_bf16 v[80:95], v[60:63], v[152:155], v[80:95]
    ds_read_b64_tr_b16 v[252:253], v20 offset:40960
    ds_read_b64_tr_b16 v[254:255], v20 offset:41216
    ds_read_b128 v[164:167], v13 offset:32768
    s_add_u32 s57, s100, 512
    s_add_u32 s58, s100, 0xfffffe80
    s_min_u32 s57, s57, s58
    s_add_u32 s57, s57, s54
    s_add_u32 m0, s76, 132096
    s_nop 0
    buffer_load_dwordx4 v3, s[8:11], s57 offen lds
    s_waitcnt lgkmcnt(9)
    v_mfma_f32_32x32x16_bf16 v[64:79], v[240:243], v[156:159], v[64:79]
    ds_read_b128 v[168:171], v14 offset:32768
    ds_read_b64_tr_b16 v[56:57], v21 offset:8192
    ds_read_b64_tr_b16 v[58:59], v21 offset:8448
    s_add_u32 s57, s100, 512
    s_add_u32 s58, s100, 0xfffffe80
    s_min_u32 s57, s57, s58
    s_add_u32 s57, s57, s54
    s_add_u32 s57, s57, 14336
    s_add_u32 m0, s76, 133120
    s_nop 0
    buffer_load_dwordx4 v2, s[8:11], s57 offen lds
    s_waitcnt lgkmcnt(10)
    v_mfma_f32_32x32x16_bf16 v[80:95], v[244:247], v[156:159], v[80:95]
    ds_read_b64_tr_b16 v[60:61], v21 offset:40960
    ds_read_b64_tr_b16 v[62:63], v21 offset:41216
    ds_read_b128 v[172:175], v15 offset:32768
    s_add_u32 s57, s100, 512
    s_add_u32 s58, s100, 0xfffffe80
    s_min_u32 s57, s57, s58
    s_add_u32 s57, s57, s54
    s_add_u32 s57, s57, 14336
    s_add_u32 m0, s76, 134144
    s_nop 0
    buffer_load_dwordx4 v3, s[8:11], s57 offen lds
    s_waitcnt lgkmcnt(10)
    v_mfma_f32_32x32x16_bf16 v[64:79], v[248:251], v[160:163], v[64:79]
    v_mfma_f32_16x16x32_bf16 v[28:31], v[248:251], v[24:27], v[28:31]
    ds_read_b64_tr_b16 v[240:241], v22 offset:8192
    ds_read_b64_tr_b16 v[242:243], v22 offset:8448
    s_waitcnt lgkmcnt(9)
    v_mfma_f32_32x32x16_bf16 v[80:95], v[252:255], v[160:163], v[80:95]
    v_mfma_f32_16x16x32_bf16 v[32:35], v[252:255], v[24:27], v[32:35]
    ds_read_b64_tr_b16 v[244:245], v22 offset:40960
    ds_read_b64_tr_b16 v[246:247], v22 offset:41216
    s_waitcnt lgkmcnt(7)
    v_mfma_f32_32x32x16_bf16 v[64:79], v[56:59], v[164:167], v[64:79]
    ds_read_b64_tr_b16 v[248:249], v23 offset:8192
    ds_read_b64_tr_b16 v[250:251], v23 offset:8448
    s_waitcnt vmcnt(10)
    v_readfirstlane_b32 s66, v6
    s_cmp_eq_u32 s66, 0
    s_cbranch_scc1 L_ns_14
L_nb_15:
    v_and_b32 v48, 2, v1
    v_cmp_ne_u32 vcc, 0, v48
    v_and_b32 v48, 1, v1
    v_lshlrev_b32 v48, 4, v48
    v_cndmask_b32 v49, v6, v7, vcc
    v_lshrrev_b32 v49, v48, v49
    v_lshlrev_b32 v8, 16, v49
    s_waitcnt lgkmcnt(7)
    v_mfma_f32_32x32x16_bf16 v[80:95], v[60:63], v[164:167], v[80:95]
    ds_read_b64_tr_b16 v[252:253], v23 offset:40960
    ds_read_b64_tr_b16 v[254:255], v23 offset:41216
    s_waitcnt lgkmcnt(6)
    v_mfma_f32_32x32x16_bf16 v[64:79], v[240:243], v[168:171], v[64:79]
    s_waitcnt vmcnt(7)
    ds_read_b128 v[176:179], v12 offset:0
    ds_read_b64_tr_b16 v[56:57], v20 offset:12288
    ds_read_b64_tr_b16 v[58:59], v20 offset:12544
    s_add_u32 s57, s100, 640
    s_add_u32 s58, s100, 0xffffff00
    s_min_u32 s57, s57, s58
    s_add_u32 s57, s57, s54
    s_add_u32 m0, s76, 98304
    s_nop 0
    buffer_load_dwordx4 v2, s[8:11], s57 offen lds
    s_waitcnt lgkmcnt(7)
    v_mfma_f32_32x32x16_bf16 v[80:95], v[244:247], v[168:171], v[80:95]
    ds_read_b64_tr_b16 v[60:61], v20 offset:45056
    ds_read_b64_tr_b16 v[62:63], v20 offset:45312
    ds_read_b128 v[180:183], v13 offset:0
    s_add_u32 s57, s100, 640
    s_add_u32 s58, s100, 0xffffff00
    s_min_u32 s57, s57, s58
    s_add_u32 s57, s57, s54
    s_add_u32 m0, s76, 99328
    s_nop 0
    buffer_load_dwordx4 v3, s[8:11], s57 offen lds
    s_waitcnt lgkmcnt(8)
    v_mfma_f32_32x32x16_bf16 v[64:79], v[248:251], v[172:175], v[64:79]
    ds_read_b128 v[184:187], v14 offset:0
    ds_read_b64_tr_b16 v[240:241], v21 offset:12288
    ds_read_b64_tr_b16 v[242:243], v21 offset:12544
    s_add_u32 s57, s100, 640
    s_add_u32 s58, s100, 0xffffff00
    s_min_u32 s57, s57, s58
    s_add_u32 s57, s57, s54
    s_add_u32 s57, s57, 14336
    s_add_u32 m0, s76, 100352
    s_nop 0
    buffer_load_dwordx4 v2, s[8:11], s57 offen lds
    s_waitcnt lgkmcnt(9)
    v_mfma_f32_32x32x16_bf16 v[80:95], v[252:255], v[172:175], v[80:95]
    ds_read_b64_tr_b16 v[244:245], v21 offset:45056
    ds_read_b64_tr_b16 v[246:247], v21 offset:45312
    ds_read_b128 v[188:191], v15 offset:0
    s_add_u32 s57, s100, 640
    s_add_u32 s58, s100, 0xffffff00
    s_min_u32 s57, s57, s58
    s_add_u32 s57, s57, s54
    s_add_u32 s57, s57, 14336
    s_add_u32 m0, s76, 101376
    s_nop 0
    buffer_load_dwordx4 v3, s[8:11], s57 offen lds
    s_waitcnt lgkmcnt(9)
    v_mfma_f32_32x32x16_bf16 v[64:79], v[56:59], v[176:179], v[64:79]
    v_mfma_f32_16x16x32_bf16 v[28:31], v[56:59], v[24:27], v[28:31]
    ds_read_b64_tr_b16 v[248:249], v22 offset:12288
    ds_read_b64_tr_b16 v[250:251], v22 offset:12544
    v_and_b32 v48, 31, v1
    v_lshlrev_b32 v48, 4, v48
    s_lshl_b32 s82, s71, 4
    s_add_u32 s82, s82, 11534336
    buffer_load_dwordx4 v[44:47], v48, s[16:19], s82 offen sc1
    s_waitcnt lgkmcnt(9)
    v_mfma_f32_32x32x16_bf16 v[80:95], v[60:63], v[176:179], v[80:95]
    v_mfma_f32_16x16x32_bf16 v[32:35], v[60:63], v[24:27], v[32:35]
    ds_read_b64_tr_b16 v[252:253], v22 offset:45056
    ds_read_b64_tr_b16 v[254:255], v22 offset:45312
    s_waitcnt lgkmcnt(7)
    v_mfma_f32_32x32x16_bf16 v[64:79], v[240:243], v[180:183], v[64:79]
    ds_read_b64_tr_b16 v[56:57], v23 offset:12288
    ds_read_b64_tr_b16 v[58:59], v23 offset:12544
    s_waitcnt lgkmcnt(7)
    v_mfma_f32_32x32x16_bf16 v[80:95], v[244:247], v[180:183], v[80:95]
    s_waitcnt vmcnt(9)
    s_barrier
    ds_read_b64_tr_b16 v[60:61], v23 offset:45056
    ds_read_b64_tr_b16 v[62:63], v23 offset:45312
    s_waitcnt lgkmcnt(6)
    v_mfma_f32_32x32x16_bf16 v[64:79], v[248:251], v[184:187], v[64:79]
    s_waitcnt vmcnt(5)
    ds_read_b128 v[192:195], v16 offset:0
    ds_read_b64_tr_b16 v[240:241], v20 offset:16384
    ds_read_b64_tr_b16 v[242:243], v20 offset:16640
    s_add_u32 s57, s100, 768
    s_add_u32 s58, s100, 0xffffff80
    s_min_u32 s57, s57, s58
    s_add_u32 s57, s57, s54
    s_add_u32 m0, s76, 65536
    s_nop 0
    buffer_load_dwordx4 v2, s[8:11], s57 offen lds
    s_waitcnt lgkmcnt(7)
    v_mfma_f32_32x32x16_bf16 v[80:95], v[252:255], v[184:187], v[80:95]
    ds_read_b64_tr_b16 v[244:245], v20 offset:49152
    ds_read_b64_tr_b16 v[246:247], v20 offset:49408
    ds_read_b128 v[196:199], v17 offset:0
    s_add_u32 s57, s100, 768
    s_add_u32 s58, s100, 0xffffff80
    s_min_u32 s57, s57, s58
    s_add_u32 s57, s57, s54
    s_add_u32 m0, s76, 66560
    s_nop 0
    buffer_load_dwordx4 v3, s[8:11], s57 offen lds
    s_waitcnt lgkmcnt(8)
    v_mfma_f32_32x32x16_bf16 v[64:79], v[56:59], v[188:191], v[64:79]
    ds_read_b128 v[200:203], v18 offset:0
    ds_read_b64_tr_b16 v[248:249], v21 offset:16384
    ds_read_b64_tr_b16 v[250:251], v21 offset:16640
    s_add_u32 s57, s100, 768
    s_add_u32 s58, s100, 0xffffff80
    s_min_u32 s57, s57, s58
    s_add_u32 s57, s57, s54
    s_add_u32 s57, s57, 14336
    s_add_u32 m0, s76, 67584
    s_nop 0
    buffer_load_dwordx4 v2, s[8:11], s57 offen lds
    s_waitcnt lgkmcnt(9)
    v_mfma_f32_32x32x16_bf16 v[80:95], v[60:63], v[188:191], v[80:95]
    ds_read_b64_tr_b16 v[252:253], v21 offset:49152
    ds_read_b64_tr_b16 v[254:255], v21 offset:49408
    ds_read_b128 v[204:207], v19 offset:0
    s_add_u32 s57, s100, 768
    s_add_u32 s58, s100, 0xffffff80
    s_min_u32 s57, s57, s58
    s_add_u32 s57, s57, s54
    s_add_u32 s57, s57, 14336
    s_add_u32 m0, s76, 68608
    s_nop 0
    buffer_load_dwordx4 v3, s[8:11], s57 offen lds
    s_waitcnt lgkmcnt(9)
    v_mfma_f32_32x32x16_bf16 v[64:79], v[240:243], v[192:195], v[64:79]
    v_mfma_f32_16x16x32_bf16 v[28:31], v[240:243], v[24:27], v[28:31]
    ds_read_b64_tr_b16 v[56:57], v22 offset:16384
    ds_read_b64_tr_b16 v[58:59], v22 offset:16640
    s_waitcnt lgkmcnt(9)
    v_mfma_f32_32x32x16_bf16 v[80:95], v[244:247], v[192:195], v[80:95]
    v_mfma_f32_16x16x32_bf16 v[32:35], v[244:247], v[24:27], v[32:35]
    ds_read_b64_tr_b16 v[60:61], v22 offset:49152
    ds_read_b64_tr_b16 v[62:63], v22 offset:49408
    v_lshrrev_b32 v48, 3, v1
    v_bfe_u32 v49, v1, 4, 1
    s_waitcnt lgkmcnt(7)
    v_mfma_f32_32x32x16_bf16 v[64:79], v[248:251], v[196:199], v[64:79]
    ds_read_b64_tr_b16 v[240:241], v23 offset:16384
    ds_read_b64_tr_b16 v[242:243], v23 offset:16640
    v_lshlrev_b32 v49, 2, v49
    v_and_b32 v2, 7, v1
    v_xor_b32 v49, v2, v49
    s_waitcnt lgkmcnt(7)
    v_mfma_f32_32x32x16_bf16 v[80:95], v[252:255], v[196:199], v[80:95]
    ds_read_b64_tr_b16 v[244:245], v23 offset:49152
    ds_read_b64_tr_b16 v[246:247], v23 offset:49408
    v_lshlrev_b32 v49, 4, v49
    v_mul_u32_u24 v2, 896, v48
    s_waitcnt lgkmcnt(6)
    v_mfma_f32_32x32x16_bf16 v[64:79], v[56:59], v[200:203], v[64:79]
    s_waitcnt vmcnt(5)
    ds_read_b128 v[208:211], v12 offset:32768
    ds_read_b64_tr_b16 v[248:249], v20 offset:20480
    ds_read_b64_tr_b16 v[250:251], v20 offset:20736
    s_add_u32 s57, s73, 0
    s_add_u32 m0, s76, 131072
    s_nop 0
    buffer_load_dwordx4 v4, s[44:47], s57 offen lds
    v_add_u32 v2, v2, v49
    v_add_u32 v3, 5, v48
    v_lshrrev_b32 v3, 3, v3
    s_waitcnt lgkmcnt(7)
    v_mfma_f32_32x32x16_bf16 v[80:95], v[60:63], v[200:203], v[80:95]
    ds_read_b64_tr_b16 v[252:253], v20 offset:53248
    ds_read_b64_tr_b16 v[254:255], v20 offset:53504
    ds_read_b128 v[212:215], v13 offset:32768
    s_add_u32 s57, s73, 43008
    s_add_u32 m0, s76, 132096
    s_nop 0
    buffer_load_dwordx4 v4, s[44:47], s57 offen lds
    v_sub_u32 v3, v48, v3
    v_add_u32 v48, 1, v48
    s_waitcnt lgkmcnt(8)
    v_mfma_f32_32x32x16_bf16 v[64:79], v[240:243], v[204:207], v[64:79]
    ds_read_b128 v[216:219], v14 offset:32768
    ds_read_b64_tr_b16 v[56:57], v21 offset:20480
    ds_read_b64_tr_b16 v[58:59], v21 offset:20736
    s_add_u32 s57, s73, 86016
    s_add_u32 m0, s76, 133120
    s_nop 0
    buffer_load_dwordx4 v4, s[44:47], s57 offen lds
    v_lshrrev_b32 v48, 3, v48
    v_sub_u32 v3, v3, v48
    v_mul_u32_u24 v3, 896, v3
    s_waitcnt lgkmcnt(9)
    v_mfma_f32_32x32x16_bf16 v[80:95], v[244:247], v[204:207], v[80:95]
    ds_read_b64_tr_b16 v[60:61], v21 offset:53248
    ds_read_b64_tr_b16 v[62:63], v21 offset:53504
    ds_read_b128 v[220:223], v15 offset:32768
    s_add_u32 s57, s73, 129024
    s_add_u32 m0, s76, 134144
    s_nop 0
    buffer_load_dwordx4 v4, s[44:47], s57 offen lds
    v_add_u32 v3, v3, v49
    v_and_b32 v9, 3, v1
    v_lshlrev_b32 v9, 3, v9
    s_waitcnt lgkmcnt(9)
    v_mfma_f32_32x32x16_bf16 v[64:79], v[248:251], v[208:211], v[64:79]
    v_mfma_f32_16x16x32_bf16 v[28:31], v[248:251], v[24:27], v[28:31]
    ds_read_b64_tr_b16 v[240:241], v22 offset:20480
    ds_read_b64_tr_b16 v[242:243], v22 offset:20736
    s_waitcnt vmcnt(8)
    v_cmp_ne_u32 s[82:83], v6, v47
    s_nop 0
    s_cmp_eq_u64 s[82:83], 0
    s_cbranch_scc0 L_ss_16
L_sb_17:
    s_waitcnt lgkmcnt(9)
    v_mfma_f32_32x32x16_bf16 v[80:95], v[252:255], v[208:211], v[80:95]
    v_mfma_f32_16x16x32_bf16 v[32:35], v[252:255], v[24:27], v[32:35]
    ds_read_b64_tr_b16 v[244:245], v22 offset:53248
    ds_read_b64_tr_b16 v[246:247], v22 offset:53504
    v_cvt_pk_bf16_f32 v48, v44, v44
    s_waitcnt lgkmcnt(7)
    v_mfma_f32_32x32x16_bf16 v[64:79], v[56:59], v[212:215], v[64:79]
    ds_read_b64_tr_b16 v[248:249], v23 offset:20480
    ds_read_b64_tr_b16 v[250:251], v23 offset:20736
    v_and_b32 v48, 0xffff0000, v48
    v_sub_f32 v48, v44, v48
    s_waitcnt lgkmcnt(7)
    v_mfma_f32_32x32x16_bf16 v[80:95], v[60:63], v[212:215], v[80:95]
    ds_read_b64_tr_b16 v[252:253], v23 offset:53248
    ds_read_b64_tr_b16 v[254:255], v23 offset:53504
    v_cvt_pk_bf16_f32 v36, v44, v48
    s_waitcnt lgkmcnt(6)
    v_mfma_f32_32x32x16_bf16 v[64:79], v[240:243], v[216:219], v[64:79]
    s_waitcnt vmcnt(4)
    ds_read_b128 v[224:227], v12 offset:0
    ds_read_b64_tr_b16 v[56:57], v20 offset:24576
    ds_read_b64_tr_b16 v[58:59], v20 offset:24832
    s_add_u32 m0, s76, 98304
    v_cvt_pk_bf16_f32 v37, v44, 0
    v_mov_b32 v38, 0
    s_waitcnt lgkmcnt(7)
    v_mfma_f32_32x32x16_bf16 v[80:95], v[244:247], v[216:219], v[80:95]
    ds_read_b64_tr_b16 v[60:61], v20 offset:57344
    ds_read_b64_tr_b16 v[62:63], v20 offset:57600
    ds_read_b128 v[228:231], v13 offset:0
    s_add_u32 s57, s3, 57344
    buffer_load_dwordx4 v2, s[24:27], s57 offen offset:0 lds
    v_mov_b32 v39, 0
    s_waitcnt lgkmcnt(8)
    v_mfma_f32_32x32x16_bf16 v[64:79], v[248:251], v[220:223], v[64:79]
    ds_read_b128 v[232:235], v14 offset:0
    ds_read_b64_tr_b16 v[240:241], v21 offset:24576
    ds_read_b64_tr_b16 v[242:243], v21 offset:24832
    s_add_u32 s57, s3, 63488
    buffer_load_dwordx4 v2, s[24:27], s57 offen offset:1024 lds
    v_cndmask_b32 v36, 0, v36, s[68:69]
    v_cndmask_b32 v37, 0, v37, s[68:69]
    s_waitcnt lgkmcnt(9)
    v_mfma_f32_32x32x16_bf16 v[80:95], v[252:255], v[220:223], v[80:95]
    ds_read_b64_tr_b16 v[244:245], v21 offset:57344
    ds_read_b64_tr_b16 v[246:247], v21 offset:57600
    ds_read_b128 v[236:239], v15 offset:0
    s_add_u32 s57, s3, 69632
    buffer_load_dwordx4 v2, s[24:27], s57 offen offset:2048 lds
    v_mul_f32 v40, 0x3fb8aa3b, v45
    v_mov_b32 v41, v45
    s_waitcnt lgkmcnt(9)
    v_mfma_f32_32x32x16_bf16 v[64:79], v[56:59], v[224:227], v[64:79]
    v_mfma_f32_16x16x32_bf16 v[28:31], v[56:59], v[24:27], v[28:31]
    ds_read_b64_tr_b16 v[248:249], v22 offset:24576
    ds_read_b64_tr_b16 v[250:251], v22 offset:24832
    s_add_u32 s57, s3, 75776
    buffer_load_dwordx4 v2, s[24:27], s57 offen offset:3072 lds
    v_add_u32 v12, 0x20000, v20
    v_add_u32 v13, 0x20000, v21
    s_waitcnt lgkmcnt(9)
    v_mfma_f32_32x32x16_bf16 v[80:95], v[60:63], v[224:227], v[80:95]
    v_mfma_f32_16x16x32_bf16 v[32:35], v[60:63], v[24:27], v[32:35]
    ds_read_b64_tr_b16 v[252:253], v22 offset:57344
    ds_read_b64_tr_b16 v[254:255], v22 offset:57600
    v_add_u32 v14, 0x20000, v22
    v_add_u32 v15, 0x20000, v23
    s_waitcnt lgkmcnt(7)
    v_mfma_f32_32x32x16_bf16 v[64:79], v[240:243], v[228:231], v[64:79]
    ds_read_b64_tr_b16 v[56:57], v23 offset:24576
    ds_read_b64_tr_b16 v[58:59], v23 offset:24832
    s_waitcnt lgkmcnt(7)
    v_mfma_f32_32x32x16_bf16 v[80:95], v[244:247], v[228:231], v[80:95]
    ds_read_b64_tr_b16 v[60:61], v23 offset:57344
    ds_read_b64_tr_b16 v[62:63], v23 offset:57600
    s_mov_b32 exec_lo, 0x00030003
    s_mov_b32 exec_hi, 0x00030003
    ds_write_b128 v43, v[28:31] offset:0
    ds_write_b128 v43, v[32:35] offset:1024
    s_mov_b64 exec, -1
    s_waitcnt vmcnt(4)
    s_waitcnt lgkmcnt(0)
    s_barrier
    v_mfma_f32_32x32x16_bf16 v[64:79], v[248:251], v[232:235], v[64:79]
    v_and_b32 v48, 31, v1
    v_lshlrev_b32 v48, 2, v48
    v_add_u32 v48, 63488, v48
    ds_read_b32 v28, v48 offset:0
    ds_read_b32 v29, v48 offset:128
    ds_read_b32 v30, v48 offset:256
    ds_read_b32 v31, v48 offset:384
    ds_read_b32 v32, v48 offset:1024
    ds_read_b32 v33, v48 offset:1152
    ds_read_b32 v34, v48 offset:1280
    ds_read_b32 v35, v48 offset:1408
    s_add_u32 m0, s76, 65536
    ds_read_b64_tr_b16 v[240:241], v12 offset:0
    ds_read_b64_tr_b16 v[242:243], v12 offset:256
    v_mfma_f32_32x32x16_bf16 v[80:95], v[252:255], v[232:235], v[80:95]
    s_add_u32 s57, s3, 229376
    buffer_load_dwordx4 v2, s[24:27], s57 offen offset:0 lds
    ds_read_b64_tr_b16 v[244:245], v13 offset:0
    ds_read_b64_tr_b16 v[246:247], v13 offset:256
    v_add_u32 v44, 6144, v2
    v_add_u32 v45, 12288, v2
    v_add_u32 v46, 18432, v2
    v_mfma_f32_32x32x16_bf16 v[64:79], v[56:59], v[236:239], v[64:79]
    s_add_u32 s57, s3, 235520
    buffer_load_dwordx4 v2, s[24:27], s57 offen offset:1024 lds
    s_waitcnt lgkmcnt(10)
    v_add_f32 v28, v28, v29
    s_waitcnt lgkmcnt(8)
    v_add_f32 v30, v30, v31
    v_add_f32 v30, v28, v30
    v_cvt_pk_bf16_f32 v28, v30, v30
    v_and_b32 v29, 0xffff0000, v28
    v_sub_f32 v29, v30, v29
    v_cvt_pk_bf16_f32 v29, v29, 0
    v_mov_b32 v30, 0
    v_mov_b32 v31, 0
    v_lshrrev_b32 v49, 5, v1
    v_lshlrev_b32 v49, 2, v49
    v_bfe_u32 v50, v1, 2, 2
    v_add_u32 v49, v49, v50
    v_lshlrev_b32 v49, 6, v49
    v_bfe_u32 v50, v1, 4, 1
    v_lshlrev_b32 v50, 5, v50
    v_add_u32 v49, v49, v50
    v_and_b32 v50, 3, v1
    v_lshl_add_u32 v49, v50, 3, v49
    v_add_u32 v49, 61440, v49
    ds_read_b64_tr_b16 v[248:249], v49 offset:0
    ds_read_b64_tr_b16 v[250:251], v49 offset:512
    ds_read_b64_tr_b16 v[252:253], v49 offset:1024
    ds_read_b64_tr_b16 v[254:255], v49 offset:1536
    v_mfma_f32_32x32x16_bf16 v[80:95], v[60:63], v[236:239], v[80:95]
    s_add_u32 s57, s3, 241664
    buffer_load_dwordx4 v2, s[24:27], s57 offen offset:2048 lds
    s_add_u32 s57, s3, 247808
    buffer_load_dwordx4 v2, s[24:27], s57 offen offset:3072 lds
    s_waitcnt lgkmcnt(10)
    v_add_f32 v32, v32, v33
    s_waitcnt lgkmcnt(8)
    v_add_f32 v34, v34, v35
    v_add_f32 v34, v32, v34
    v_cvt_pk_bf16_f32 v32, v34, v34
    v_and_b32 v33, 0xffff0000, v32
    v_sub_f32 v33, v34, v33
    v_cvt_pk_bf16_f32 v33, v33, 0
    v_mov_b32 v34, 0
    v_mov_b32 v35, 0
    v_mfma_f32_32x32x16_bf16 v[64:79], v[28:31], v[36:39], v[64:79]
    s_nop 0
    v_mfma_f32_32x32x16_bf16 v[80:95], v[32:35], v[36:39], v[80:95]
    s_and_b32 s57, s2, 0x78
    s_add_u32 s57, s57, s48
    s_mul_i32 s58, s57, 9363
    s_lshr_b32 s58, s58, 16
    s_mul_i32 s59, s58, 7
    s_sub_u32 s59, s57, s59
    s_lshl_b32 s59, s59, 13
    s_lshr_b32 s60, s58, 1
    s_mul_i32 s60, s60, 401408
    s_add_u32 s59, s59, s60
    s_and_b32 s58, s58, 1
    s_mul_i32 s58, s58, 172032
    s_add_u32 s59, s59, s58
    s_add_u32 s59, s59, 172032
    s_cmp_ge_u32 s57, 56
    s_cselect_b32 s59, 2147483632, s59
    v_lshlrev_b32 v55, 7, v1
    buffer_load_dword v32, v55, s[24:27], s59 offen
    s_and_b32 s57, s2, 0x78
    s_add_u32 s57, s57, s48
    s_sub_u32 s57, s57, 56
    s_lshl_b32 s58, s57, 13
    s_cmp_ge_u32 s57, 49
    s_cselect_b32 s58, 2147483632, s58
    buffer_load_dword v33, v55, s[28:31], s58 offen
    v_cvt_pk_bf16_f32 v64, v64, v65
    v_cvt_pk_bf16_f32 v65, v66, v67
    v_cvt_pk_bf16_f32 v66, v68, v69
    v_cvt_pk_bf16_f32 v67, v70, v71
    v_cvt_pk_bf16_f32 v68, v72, v73
    v_cvt_pk_bf16_f32 v69, v74, v75
    v_cvt_pk_bf16_f32 v70, v76, v77
    v_cvt_pk_bf16_f32 v71, v78, v79
    v_cndmask_b32 v70, 0, v70, s[68:69]
    v_cndmask_b32 v71, 0, v71, s[68:69]
    s_waitcnt lgkmcnt(2)
    v_mfma_f32_32x32x16_bf16 v[112:127], v[248:251], v[64:67], 0
    s_waitcnt lgkmcnt(0)
    v_mfma_f32_32x32x16_bf16 v[112:127], v[252:255], v[68:71], v[112:127]
    v_and_b32 v53, 31, v1
    v_lshrrev_b32 v54, 5, v1
    v_lshrrev_b32 v55, 2, v53
    v_xor_b32 v55, v55, v54
    v_bfe_u32 v54, v53, 1, 1
    v_lshl_add_u32 v54, v54, 3, v55
    v_lshlrev_b32 v54, 3, v54
    v_lshl_add_u32 v16, v53, 7, v54
    v_add_u32 v16, s76, v16
    v_lshlrev_b32 v55, 3, v55
    v_lshl_add_u32 v17, v53, 6, v55
    s_lshr_b32 s57, s76, 1
    s_add_u32 s57, s57, 32768
    v_add_u32 v17, s57, v17
    v_max3_f32 v48, v112, v113, v114
    v_min3_f32 v49, v112, v113, v114
    v_max3_f32 v48, v48, v115, v116
    v_min3_f32 v49, v49, v115, v116
    v_max3_f32 v48, v48, v117, v118
    v_min3_f32 v49, v49, v117, v118
    v_max3_f32 v48, v48, v120, v121
    v_min3_f32 v49, v49, v120, v121
    v_max3_f32 v48, v48, v122, v123
    v_min3_f32 v49, v49, v122, v123
    v_max3_f32 v48, v48, v124, v125
    v_min3_f32 v49, v49, v124, v125
    v_max_f32 v48, v48, v126
    v_min_f32 v49, v49, v126
    v_xor_b32 v49, 0x80000000, v49
    s_nop 1
    v_permlane32_swap_b32 v48, v49
    v_max_f32 v48, v48, v49
    v_mov_b32 v49, v48
    s_nop 1
    v_permlane32_swap_b32 v48, v49
    v_mul_f32 v48, -v40, v48
    v_mul_f32 v49, -v40, v49
    v_fma_f32 v64, v112, v40, v48
    v_fma_f32 v112, -v112, v40, v49
    v_exp_f32 v64, v64
    v_exp_f32 v112, v112
    v_fma_f32 v65, v113, v40, v48
    v_fma_f32 v113, -v113, v40, v49
    v_exp_f32 v65, v65
    v_exp_f32 v113, v113
    v_fma_f32 v66, v114, v40, v48
    v_fma_f32 v114, -v114, v40, v49
    v_exp_f32 v66, v66
    v_exp_f32 v114, v114
    v_fma_f32 v67, v115, v40, v48
    v_fma_f32 v115, -v115, v40, v49
    v_exp_f32 v67, v67
    v_exp_f32 v115, v115
    v_fma_f32 v68, v116, v40, v48
    v_fma_f32 v116, -v116, v40, v49
    v_exp_f32 v68, v68
    v_exp_f32 v116, v116
    v_fma_f32 v69, v117, v40, v48
    v_fma_f32 v117, -v117, v40, v49
    v_exp_f32 v69, v69
    v_exp_f32 v117, v117
    v_fma_f32 v70, v118, v40, v48
    v_fma_f32 v118, -v118, v40, v49
    v_exp_f32 v70, v70
    v_exp_f32 v118, v118
    v_fma_f32 v72, v120, v40, v48
    v_fma_f32 v120, -v120, v40, v49
    v_exp_f32 v72, v72
    v_exp_f32 v120, v120
    v_fma_f32 v73, v121, v40, v48
    v_fma_f32 v121, -v121, v40, v49
    v_exp_f32 v73, v73
    v_exp_f32 v121, v121
    v_fma_f32 v74, v122, v40, v48
    v_fma_f32 v122, -v122, v40, v49
    v_exp_f32 v74, v74
    v_exp_f32 v122, v122
    v_fma_f32 v75, v123, v40, v48
    v_fma_f32 v123, -v123, v40, v49
    v_exp_f32 v75, v75
    v_exp_f32 v123, v123
    v_fma_f32 v76, v124, v40, v48
    v_fma_f32 v124, -v124, v40, v49
    v_exp_f32 v76, v76
    v_exp_f32 v124, v124
    v_fma_f32 v77, v125, v40, v48
    v_fma_f32 v125, -v125, v40, v49
    v_exp_f32 v77, v77
    v_exp_f32 v125, v125
    v_fma_f32 v78, v126, v40, v48
    v_fma_f32 v126, -v126, v40, v49
    v_exp_f32 v78, v78
    v_exp_f32 v126, v126
    v_add_f32 v48, v64, v65
    v_add_f32 v50, v72, v73
    v_add_f32 v48, v48, v66
    v_add_f32 v50, v50, v74
    v_add_f32 v48, v48, v67
    v_add_f32 v50, v50, v75
    v_add_f32 v48, v48, v68
    v_add_f32 v50, v50, v76
    v_add_f32 v48, v48, v69
    v_add_f32 v50, v50, v77
    v_add_f32 v48, v48, v70
    v_add_f32 v50, v50, v78
    v_add_f32 v48, v48, v50
    v_add_f32 v49, v112, v113
    v_add_f32 v51, v120, v121
    v_add_f32 v49, v49, v114
    v_add_f32 v51, v51, v122
    v_add_f32 v49, v49, v115
    v_add_f32 v51, v51, v123
    v_add_f32 v49, v49, v116
    v_add_f32 v51, v51, v124
    v_add_f32 v49, v49, v117
    v_add_f32 v51, v51, v125
    v_add_f32 v49, v49, v118
    v_add_f32 v51, v51, v126
    v_add_f32 v49, v49, v51
    s_nop 1
    v_permlane32_swap_b32 v48, v49
    v_add_f32 v48, v48, v49
    v_mov_b32 v49, v48
    s_nop 1
    v_permlane32_swap_b32 v48, v49
    v_rcp_f32 v50, v48
    v_rcp_f32 v51, v49
    s_nop 0
    v_mul_f32 v51, v51, v48
    v_mul_f32 v52, v50, v41
    v_cvt_pk_bf16_f32 v64, v64, v65
    v_cvt_pk_bf16_f32 v65, v66, v67
    v_cvt_pk_bf16_f32 v66, v68, v69
    v_cvt_pk_bf16_f32 v67, v70, 0
    v_cvt_pk_bf16_f32 v68, v72, v73
    v_cvt_pk_bf16_f32 v69, v74, v75
    v_cvt_pk_bf16_f32 v70, v76, v77
    v_cvt_pk_bf16_f32 v71, v78, 0
    ds_write_b64 v16, v[64:65] offset:0
    v_xor_b32 v54, 16, v16
    ds_write_b64 v54, v[66:67] offset:0
    v_xor_b32 v53, 32, v16
    ds_write_b64 v53, v[68:69] offset:0
    v_xor_b32 v54, 48, v16
    ds_write_b64 v54, v[70:71] offset:0
    v_mul_f32 v112, v112, v51
    v_mul_f32 v113, v113, v51
    v_mul_f32 v114, v114, v51
    v_mul_f32 v115, v115, v51
    v_mul_f32 v116, v116, v51
    v_mul_f32 v117, v117, v51
    v_mul_f32 v118, v118, v51
    v_mul_f32 v120, v120, v51
    v_mul_f32 v121, v121, v51
    v_mul_f32 v122, v122, v51
    v_mul_f32 v123, v123, v51
    v_mul_f32 v124, v124, v51
    v_mul_f32 v125, v125, v51
    v_mul_f32 v126, v126, v51
    v_cvt_pk_bf16_f32 v112, v112, v113
    v_cvt_pk_bf16_f32 v113, v114, v115
    v_cvt_pk_bf16_f32 v114, v116, v117
    v_cvt_pk_bf16_f32 v115, v118, 0
    v_cvt_pk_bf16_f32 v116, v120, v121
    v_cvt_pk_bf16_f32 v117, v122, v123
    v_cvt_pk_bf16_f32 v118, v124, v125
    v_cvt_pk_bf16_f32 v119, v126, 0
    v_xor_b32 v53, 64, v16
    ds_write_b64 v53, v[112:113] offset:0
    v_xor_b32 v54, 80, v16
    ds_write_b64 v54, v[114:115] offset:0
    v_xor_b32 v53, 96, v16
    ds_write_b64 v53, v[116:117] offset:0
    v_xor_b32 v54, 112, v16
    ds_write_b64 v54, v[118:119] offset:0
    v_mul_f32 v80, v80, v52
    v_mul_f32 v81, v81, v52
    v_mul_f32 v82, v82, v52
    v_mul_f32 v83, v83, v52
    v_mul_f32 v84, v84, v52
    v_mul_f32 v85, v85, v52
    v_mul_f32 v86, v86, v52
    v_mul_f32 v87, v87, v52
    v_mul_f32 v88, v88, v52
    v_mul_f32 v89, v89, v52
    v_mul_f32 v90, v90, v52
    v_mul_f32 v91, v91, v52
    v_mul_f32 v92, v92, v52
    v_mul_f32 v93, v93, v52
    v_mul_f32 v94, v94, v52
    v_mul_f32 v95, v95, v52
    v_cndmask_b32 v92, v50, v92, s[68:69]
    v_cvt_pk_bf16_f32 v80, v80, v81
    v_cvt_pk_bf16_f32 v81, v82, v83
    v_cvt_pk_bf16_f32 v82, v84, v85
    v_cvt_pk_bf16_f32 v83, v86, v87
    v_cvt_pk_bf16_f32 v84, v88, v89
    v_cvt_pk_bf16_f32 v85, v90, v91
    v_cvt_pk_bf16_f32 v86, v92, v93
    v_cvt_pk_bf16_f32 v87, v94, v95
    ds_write_b64 v17, v[80:81]
    v_xor_b32 v54, 16, v17
    ds_write_b64 v54, v[82:83]
    v_xor_b32 v53, 32, v17
    ds_write_b64 v53, v[84:85]
    v_xor_b32 v54, 48, v17
    ds_write_b64 v54, v[86:87]
    v_bfe_u32 v48, v1, 4, 1
    v_lshrrev_b32 v49, 5, v1
    v_lshlrev_b32 v50, 2, v48
    v_lshl_add_u32 v50, v49, 1, v50
    v_lshlrev_b32 v48, 4, v48
    v_lshl_add_u32 v48, v49, 3, v48
    v_bfe_u32 v49, v1, 2, 2
    v_add_u32 v48, v48, v49
    v_and_b32 v51, 3, v1
    s_lshr_b32 s57, s48, 1
    s_lshl_b32 s57, s57, 2
    s_and_b32 s58, s48, 1
    s_lshl_b32 s58, s58, 2
    v_add_u32 v18, s58, v51
    v_xor_b32 v18, v18, v50
    v_lshlrev_b32 v18, 3, v18
    v_lshl_add_u32 v18, v48, 6, v18
    v_xor_b32 v19, 8, v18
    v_add_u32 v16, s57, v51
    v_lshrrev_b32 v49, 1, v49
    v_lshl_add_u32 v50, v49, 3, v50
    v_xor_b32 v16, v16, v50
    v_lshlrev_b32 v16, 3, v16
    v_lshl_add_u32 v16, v48, 7, v16
    v_xor_b32 v17, 8, v16
    s_waitcnt lgkmcnt(0)
    s_barrier
    ds_read_b64_tr_b16 v[80:81], v16 offset:0
    ds_read_b64_tr_b16 v[82:83], v17 offset:512
    ds_read_b64_tr_b16 v[84:85], v18 offset:32768
    ds_read_b64_tr_b16 v[86:87], v19 offset:33024
    ds_read_b64_tr_b16 v[88:89], v16 offset:4096
    ds_read_b64_tr_b16 v[90:91], v17 offset:4608
    ds_read_b64_tr_b16 v[92:93], v18 offset:34816
    ds_read_b64_tr_b16 v[94:95], v19 offset:35072
    ds_read_b64_tr_b16 v[96:97], v16 offset:8192
    ds_read_b64_tr_b16 v[98:99], v17 offset:8704
    ds_read_b64_tr_b16 v[100:101], v18 offset:36864
    ds_read_b64_tr_b16 v[102:103], v19 offset:37120
    ds_read_b64_tr_b16 v[104:105], v16 offset:12288
    ds_read_b64_tr_b16 v[106:107], v17 offset:12800
    ds_read_b64_tr_b16 v[108:109], v18 offset:38912
    ds_read_b64_tr_b16 v[110:111], v19 offset:39168
    s_waitcnt lgkmcnt(12)
    v_mfma_f32_16x16x32_bf16 v[64:67], v[80:83], v[84:87], 0
    ds_read_b64_tr_b16 v[80:81], v16 offset:16384
    ds_read_b64_tr_b16 v[82:83], v17 offset:16896
    ds_read_b64_tr_b16 v[84:85], v18 offset:40960
    ds_read_b64_tr_b16 v[86:87], v19 offset:41216
    s_waitcnt lgkmcnt(12)
    v_mfma_f32_16x16x32_bf16 v[64:67], v[88:91], v[92:95], v[64:67]
    ds_read_b64_tr_b16 v[88:89], v16 offset:20480
    ds_read_b64_tr_b16 v[90:91], v17 offset:20992
    ds_read_b64_tr_b16 v[92:93], v18 offset:43008
    ds_read_b64_tr_b16 v[94:95], v19 offset:43264
    s_waitcnt lgkmcnt(12)
    v_mfma_f32_16x16x32_bf16 v[64:67], v[96:99], v[100:103], v[64:67]
    ds_read_b64_tr_b16 v[96:97], v16 offset:24576
    ds_read_b64_tr_b16 v[98:99], v17 offset:25088
    ds_read_b64_tr_b16 v[100:101], v18 offset:45056
    ds_read_b64_tr_b16 v[102:103], v19 offset:45312
    s_waitcnt lgkmcnt(12)
    v_mfma_f32_16x16x32_bf16 v[64:67], v[104:107], v[108:111], v[64:67]
    ds_read_b64_tr_b16 v[104:105], v16 offset:28672
    ds_read_b64_tr_b16 v[106:107], v17 offset:29184
    ds_read_b64_tr_b16 v[108:109], v18 offset:47104
    ds_read_b64_tr_b16 v[110:111], v19 offset:47360
    s_waitcnt lgkmcnt(12)
    v_mfma_f32_16x16x32_bf16 v[64:67], v[80:83], v[84:87], v[64:67]
    s_waitcnt lgkmcnt(8)
    v_mfma_f32_16x16x32_bf16 v[64:67], v[88:91], v[92:95], v[64:67]
    s_waitcnt lgkmcnt(4)
    v_mfma_f32_16x16x32_bf16 v[64:67], v[96:99], v[100:103], v[64:67]
    s_waitcnt lgkmcnt(0)
    v_mfma_f32_16x16x32_bf16 v[64:67], v[104:107], v[108:111], v[64:67]
    s_nop 7
    v_cvt_pk_bf16_f32 v68, v64, v65
    v_cvt_pk_bf16_f32 v69, v66, v67
    v_cvt_pk_bf16_f32 v70, v66, 0
    v_or_b32 v70, v8, v70
    v_cndmask_b32 v69, v70, v69, s[68:69]
    v_bfe_u32 v64, v1, 4, 1
    v_lshlrev_b32 v64, 9, v64
    v_and_b32 v65, 15, v1
    v_lshl_add_u32 v64, v65, 4, v64
    v_permlane32_swap_b32 v68, v70
    v_permlane32_swap_b32 v69, v71
    s_lshl_b32 s57, s52, 3
    s_add_u32 s57, s57, s51
    s_lshl_b32 s57, s57, 2
    s_lshr_b32 s58, s48, 1
    s_add_u32 s57, s57, s58
    s_lshl_b32 s57, s57, 10
    s_and_b32 s58, s48, 1
    s_lshl_b32 s58, s58, 8
    s_add_u32 s57, s57, s58
    s_add_u32 s57, s57, 10485760
    s_mov_b32 exec_hi, 0
    buffer_store_dwordx4 v[68:71], v64, s[16:19], s57 offen sc1
    s_mov_b32 exec_hi, -1
    v_mfma_f32_32x32x16_bf16 v[96:111], v[240:243], v[128:131], 0
    v_mfma_f32_16x16x32_bf16 v[60:63], v[240:243], v[24:27], 0
    ds_read_b64_tr_b16 v[56:57], v14 offset:0
    ds_read_b64_tr_b16 v[58:59], v14 offset:256
    v_mfma_f32_32x32x16_bf16 v[96:111], v[244:247], v[132:135], v[96:111]
    ds_read_b64_tr_b16 v[240:241], v15 offset:0
    ds_read_b64_tr_b16 v[242:243], v15 offset:256
    s_waitcnt lgkmcnt(2)
    v_mfma_f32_32x32x16_bf16 v[96:111], v[56:59], v[136:139], v[96:111]
    ds_read_b64_tr_b16 v[244:245], v12 offset:8192
    ds_read_b64_tr_b16 v[246:247], v12 offset:8448
    v_and_b32 v53, 31, v1
    s_waitcnt lgkmcnt(2)
    v_mfma_f32_32x32x16_bf16 v[96:111], v[240:243], v[140:143], v[96:111]
    ds_read_b64_tr_b16 v[56:57], v13 offset:8192
    ds_read_b64_tr_b16 v[58:59], v13 offset:8448
    v_add_u32 v54, 4, v53
    s_waitcnt lgkmcnt(2)
    v_mfma_f32_32x32x16_bf16 v[96:111], v[244:247], v[144:147], v[96:111]
    v_mfma_f32_16x16x32_bf16 v[60:63], v[244:247], v[24:27], v[60:63]
    ds_read_b64_tr_b16 v[240:241], v14 offset:8192
    ds_read_b64_tr_b16 v[242:243], v14 offset:8448
    v_lshrrev_b32 v54, 4, v54
    v_lshrrev_b32 v18, 4, v53
    s_waitcnt lgkmcnt(2)
    v_mfma_f32_32x32x16_bf16 v[96:111], v[56:59], v[148:151], v[96:111]
    ds_read_b64_tr_b16 v[244:245], v15 offset:8192
    ds_read_b64_tr_b16 v[246:247], v15 offset:8448
    v_add_u32 v54, v54, v18
    s_waitcnt lgkmcnt(2)
    v_mfma_f32_32x32x16_bf16 v[96:111], v[240:243], v[152:155], v[96:111]
    ds_read_b64_tr_b16 v[56:57], v12 offset:16384
    ds_read_b64_tr_b16 v[58:59], v12 offset:16640
    v_sub_u32 v18, v53, v54
    v_and_b32 v53, 11, v53
    s_waitcnt lgkmcnt(2)
    v_mfma_f32_32x32x16_bf16 v[96:111], v[244:247], v[156:159], v[96:111]
    ds_read_b64_tr_b16 v[240:241], v13 offset:16384
    ds_read_b64_tr_b16 v[242:243], v13 offset:16640
    v_cmp_eq_u32 vcc, 11, v53
    s_waitcnt lgkmcnt(2)
    v_mfma_f32_32x32x16_bf16 v[96:111], v[56:59], v[160:163], v[96:111]
    v_mfma_f32_16x16x32_bf16 v[60:63], v[56:59], v[24:27], v[60:63]
    ds_read_b64_tr_b16 v[244:245], v14 offset:16384
    ds_read_b64_tr_b16 v[246:247], v14 offset:16640
    v_mov_b32 v53, 28
    s_waitcnt lgkmcnt(2)
    v_mfma_f32_32x32x16_bf16 v[96:111], v[240:243], v[164:167], v[96:111]
    ds_read_b64_tr_b16 v[56:57], v15 offset:16384
    ds_read_b64_tr_b16 v[58:59], v15 offset:16640
    v_cndmask_b32 v18, v18, v53, vcc
    v_and_b32 v53, 32, v1
    s_waitcnt lgkmcnt(2)
    v_mfma_f32_32x32x16_bf16 v[96:111], v[244:247], v[168:171], v[96:111]
    ds_read_b64_tr_b16 v[240:241], v12 offset:24576
    ds_read_b64_tr_b16 v[242:243], v12 offset:24832
    v_add_u32 v18, v18, v53
    s_waitcnt lgkmcnt(2)
    v_mfma_f32_32x32x16_bf16 v[96:111], v[56:59], v[172:175], v[96:111]
    ds_read_b64_tr_b16 v[244:245], v13 offset:24576
    ds_read_b64_tr_b16 v[246:247], v13 offset:24832
    v_lshlrev_b32 v18, 4, v18
    v_add_u32 v18, 53248, v18
    s_waitcnt lgkmcnt(2)
    v_mfma_f32_32x32x16_bf16 v[96:111], v[240:243], v[176:179], v[96:111]
    v_mfma_f32_16x16x32_bf16 v[60:63], v[240:243], v[24:27], v[60:63]
    ds_read_b64_tr_b16 v[56:57], v14 offset:24576
    ds_read_b64_tr_b16 v[58:59], v14 offset:24832
    s_waitcnt lgkmcnt(2)
    v_mfma_f32_32x32x16_bf16 v[96:111], v[244:247], v[180:183], v[96:111]
    ds_read_b64_tr_b16 v[240:241], v15 offset:24576
    ds_read_b64_tr_b16 v[242:243], v15 offset:24832
    s_waitcnt lgkmcnt(2)
    v_mfma_f32_32x32x16_bf16 v[96:111], v[56:59], v[184:187], v[96:111]
    ds_read_b64_tr_b16 v[244:245], v12 offset:4096
    ds_read_b64_tr_b16 v[246:247], v12 offset:4352
    s_waitcnt lgkmcnt(2)
    v_mfma_f32_32x32x16_bf16 v[96:111], v[240:243], v[188:191], v[96:111]
    ds_read_b64_tr_b16 v[56:57], v13 offset:4096
    ds_read_b64_tr_b16 v[58:59], v13 offset:4352
    s_waitcnt lgkmcnt(2)
    v_mfma_f32_32x32x16_bf16 v[96:111], v[244:247], v[192:195], v[96:111]
    v_mfma_f32_16x16x32_bf16 v[60:63], v[244:247], v[24:27], v[60:63]
    ds_read_b64_tr_b16 v[240:241], v14 offset:4096
    ds_read_b64_tr_b16 v[242:243], v14 offset:4352
    s_waitcnt lgkmcnt(2)
    v_mfma_f32_32x32x16_bf16 v[96:111], v[56:59], v[196:199], v[96:111]
    ds_read_b64_tr_b16 v[244:245], v15 offset:4096
    ds_read_b64_tr_b16 v[246:247], v15 offset:4352
    s_waitcnt lgkmcnt(2)
    v_mfma_f32_32x32x16_bf16 v[96:111], v[240:243], v[200:203], v[96:111]
    ds_read_b64_tr_b16 v[56:57], v12 offset:12288
    ds_read_b64_tr_b16 v[58:59], v12 offset:12544
    s_waitcnt lgkmcnt(2)
    v_mfma_f32_32x32x16_bf16 v[96:111], v[244:247], v[204:207], v[96:111]
    ds_read_b64_tr_b16 v[240:241], v13 offset:12288
    ds_read_b64_tr_b16 v[242:243], v13 offset:12544
    s_waitcnt lgkmcnt(2)
    v_mfma_f32_32x32x16_bf16 v[96:111], v[56:59], v[208:211], v[96:111]
    v_mfma_f32_16x16x32_bf16 v[60:63], v[56:59], v[24:27], v[60:63]
    ds_read_b64_tr_b16 v[244:245], v14 offset:12288
    ds_read_b64_tr_b16 v[246:247], v14 offset:12544
    s_waitcnt lgkmcnt(2)
    v_mfma_f32_32x32x16_bf16 v[96:111], v[240:243], v[212:215], v[96:111]
    ds_read_b64_tr_b16 v[56:57], v15 offset:12288
    ds_read_b64_tr_b16 v[58:59], v15 offset:12544
    s_waitcnt lgkmcnt(2)
    v_mfma_f32_32x32x16_bf16 v[96:111], v[244:247], v[216:219], v[96:111]
    ds_read_b64_tr_b16 v[240:241], v12 offset:20480
    ds_read_b64_tr_b16 v[242:243], v12 offset:20736
    s_waitcnt lgkmcnt(2)
    v_mfma_f32_32x32x16_bf16 v[96:111], v[56:59], v[220:223], v[96:111]
    ds_read_b64_tr_b16 v[244:245], v13 offset:20480
    ds_read_b64_tr_b16 v[246:247], v13 offset:20736
    s_waitcnt lgkmcnt(2)
    v_mfma_f32_32x32x16_bf16 v[96:111], v[240:243], v[224:227], v[96:111]
    v_mfma_f32_16x16x32_bf16 v[60:63], v[240:243], v[24:27], v[60:63]
    ds_read_b64_tr_b16 v[56:57], v14 offset:20480
    ds_read_b64_tr_b16 v[58:59], v14 offset:20736
    s_waitcnt lgkmcnt(2)
    v_mfma_f32_32x32x16_bf16 v[96:111], v[244:247], v[228:231], v[96:111]
    ds_read_b64_tr_b16 v[240:241], v15 offset:20480
    ds_read_b64_tr_b16 v[242:243], v15 offset:20736
    s_waitcnt lgkmcnt(2)
    v_mfma_f32_32x32x16_bf16 v[96:111], v[56:59], v[232:235], v[96:111]
    v_add_u32 v43, -14336, v43
    s_mov_b32 exec_lo, 0x00030003
    s_mov_b32 exec_hi, 0x00030003
    ds_write_b128 v43, v[60:63] offset:0
    s_mov_b64 exec, -1
    s_waitcnt lgkmcnt(1)
    v_mfma_f32_32x32x16_bf16 v[96:111], v[240:243], v[236:239], v[96:111]
    s_waitcnt lgkmcnt(0)
    s_barrier
    v_and_b32 v54, 31, v1
    v_lshlrev_b32 v54, 2, v54
    v_add_u32 v54, 49152, v54
    ds_read_b32 v28, v54 offset:0
    ds_read_b32 v29, v54 offset:128
    ds_read_b32 v30, v54 offset:256
    ds_read_b32 v31, v54 offset:384
    s_add_u32 s57, s3, 0
    s_add_u32 m0, s76, 131072
    s_nop 0
    buffer_load_dwordx4 v2, s[24:27], s57 offen offset:0 lds
    buffer_load_dwordx4 v44, s[24:27], s57 offen offset:1024 lds
    buffer_load_dwordx4 v45, s[24:27], s57 offen offset:2048 lds
    buffer_load_dwordx4 v46, s[24:27], s57 offen offset:3072 lds
    s_add_u32 s57, s3, 286720
    s_add_u32 m0, s76, 0
    s_nop 0
    buffer_load_dwordx4 v2, s[24:27], s57 offen offset:0 lds
    buffer_load_dwordx4 v44, s[24:27], s57 offen offset:1024 lds
    buffer_load_dwordx4 v45, s[24:27], s57 offen offset:2048 lds
    buffer_load_dwordx4 v46, s[24:27], s57 offen offset:3072 lds
    s_waitcnt lgkmcnt(2)
    v_add_f32 v28, v28, v29
    s_waitcnt lgkmcnt(0)
    v_add_f32 v30, v30, v31
    v_add_f32 v30, v28, v30
    v_cvt_pk_bf16_f32 v28, v30, v30
    v_and_b32 v29, 0xffff0000, v28
    v_sub_f32 v29, v30, v29
    v_cvt_pk_bf16_f32 v29, v29, 0
    v_mov_b32 v30, 0
    v_mov_b32 v31, 0
    s_nop 1
    v_mfma_f32_32x32x16_bf16 v[96:111], v[28:31], v[36:39], v[96:111]
    s_nop 11
    v_cvt_pk_bf16_f32 v96, v96, v97
    v_cvt_pk_bf16_f32 v97, v98, v99
    v_cvt_pk_bf16_f32 v98, v100, v101
    s_add_u32 s59, s3, 172032
    buffer_load_dwordx4 v[192:195], v2, s[24:27], s59 offen offset:0
    v_cvt_pk_bf16_f32 v99, v102, v103
    v_cvt_pk_bf16_f32 v100, v104, v105
    v_cvt_pk_bf16_f32 v101, v106, v107
    v_cvt_pk_bf16_f32 v102, v108, v109
    v_cvt_pk_bf16_f32 v103, v110, v111
    v_cndmask_b32 v102, 0, v102, s[68:69]
    v_cndmask_b32 v103, 0, v103, s[68:69]
    v_mfma_f32_32x32x16_bf16 v[112:127], v[248:251], v[96:99], 0
    s_nop 0
    v_mfma_f32_32x32x16_bf16 v[112:127], v[252:255], v[100:103], v[112:127]
    s_nop 11
    v_max3_f32 v48, v112, v113, v114
    v_min3_f32 v49, v112, v113, v114
    v_max3_f32 v48, v48, v115, v116
    v_min3_f32 v49, v49, v115, v116
    v_max3_f32 v48, v48, v117, v118
    v_min3_f32 v49, v49, v117, v118
    s_add_u32 s59, s3, 172032
    buffer_load_dwordx4 v[196:199], v44, s[24:27], s59 offen offset:1024
    v_max3_f32 v48, v48, v120, v121
    v_min3_f32 v49, v49, v120, v121
    v_max3_f32 v48, v48, v122, v123
    v_min3_f32 v49, v49, v122, v123
    v_max3_f32 v48, v48, v124, v125
    v_min3_f32 v49, v49, v124, v125
    v_max_f32 v48, v48, v126
    v_min_f32 v49, v49, v126
    v_xor_b32 v49, 0x80000000, v49
    s_nop 1
    v_permlane32_swap_b32 v48, v49
    v_max_f32 v48, v48, v49
    v_mov_b32 v49, v48
    s_nop 1
    v_permlane32_swap_b32 v48, v49
    v_mul_f32 v48, -v40, v48
    v_mul_f32 v49, -v40, v49
    v_fma_f32 v96, v112, v40, v48
    s_add_u32 s59, s3, 172032
    buffer_load_dwordx4 v[200:203], v45, s[24:27], s59 offen offset:2048
    v_fma_f32 v112, -v112, v40, v49
    v_exp_f32 v96, v96
    v_exp_f32 v112, v112
    v_fma_f32 v97, v113, v40, v48
    v_fma_f32 v113, -v113, v40, v49
    v_exp_f32 v97, v97
    v_exp_f32 v113, v113
    v_fma_f32 v98, v114, v40, v48
    v_fma_f32 v114, -v114, v40, v49
    v_exp_f32 v98, v98
    v_exp_f32 v114, v114
    v_fma_f32 v99, v115, v40, v48
    v_fma_f32 v115, -v115, v40, v49
    v_exp_f32 v99, v99
    v_exp_f32 v115, v115
    s_add_u32 s59, s3, 172032
    buffer_load_dwordx4 v[204:207], v46, s[24:27], s59 offen offset:3072
    v_fma_f32 v100, v116, v40, v48
    v_fma_f32 v116, -v116, v40, v49
    v_exp_f32 v100, v100
    v_exp_f32 v116, v116
    v_fma_f32 v101, v117, v40, v48
    v_fma_f32 v117, -v117, v40, v49
    v_exp_f32 v101, v101
    v_exp_f32 v117, v117
    buffer_load_dwordx2 v[10:11], v9, s[16:19], s77 offen offset:0 sc1
    v_fma_f32 v102, v118, v40, v48
    v_fma_f32 v118, -v118, v40, v49
    v_exp_f32 v102, v102
    v_exp_f32 v118, v118
    v_fma_f32 v104, v120, v40, v48
    v_fma_f32 v120, -v120, v40, v49
    v_exp_f32 v104, v104
    s_add_u32 s59, s3, 344064
    buffer_load_dwordx4 v[208:211], v2, s[24:27], s59 offen offset:0
    v_exp_f32 v120, v120
    v_fma_f32 v105, v121, v40, v48
    v_fma_f32 v121, -v121, v40, v49
    v_exp_f32 v105, v105
    v_exp_f32 v121, v121
    v_fma_f32 v106, v122, v40, v48
    v_fma_f32 v122, -v122, v40, v49
    v_exp_f32 v106, v106
    v_exp_f32 v122, v122
    v_fma_f32 v107, v123, v40, v48
    v_fma_f32 v123, -v123, v40, v49
    v_exp_f32 v107, v107
    v_exp_f32 v123, v123
    v_fma_f32 v108, v124, v40, v48
    v_fma_f32 v124, -v124, v40, v49
    s_add_u32 s59, s3, 344064
    buffer_load_dwordx4 v[212:215], v44, s[24:27], s59 offen offset:1024
    v_exp_f32 v108, v108
    v_exp_f32 v124, v124
    v_fma_f32 v109, v125, v40, v48
    v_fma_f32 v125, -v125, v40, v49
    v_exp_f32 v109, v109
    v_exp_f32 v125, v125
    v_fma_f32 v110, v126, v40, v48
    v_fma_f32 v126, -v126, v40, v49
    v_exp_f32 v110, v110
    v_exp_f32 v126, v126
    v_add_f32 v48, v96, v97
    v_add_f32 v50, v104, v105
    v_add_f32 v48, v48, v98
    v_add_f32 v50, v50, v106
    v_add_f32 v48, v48, v99
    v_add_f32 v50, v50, v107
    s_add_u32 s59, s3, 344064
    buffer_load_dwordx4 v[216:219], v45, s[24:27], s59 offen offset:2048
    v_add_f32 v48, v48, v100
    v_add_f32 v50, v50, v108
    v_add_f32 v48, v48, v101
    v_add_f32 v50, v50, v109
    v_add_f32 v48, v48, v102
    v_add_f32 v50, v50, v110
    v_add_f32 v48, v48, v50
    v_add_f32 v49, v112, v113
    v_add_f32 v51, v120, v121
    v_add_f32 v49, v49, v114
    v_add_f32 v51, v51, v122
    v_add_f32 v49, v49, v115
    v_add_f32 v51, v51, v123
    v_add_f32 v49, v49, v116
    v_add_f32 v51, v51, v124
    s_add_u32 s59, s3, 344064
    buffer_load_dwordx4 v[220:223], v46, s[24:27], s59 offen offset:3072
    v_add_f32 v49, v49, v117
    v_add_f32 v51, v51, v125
    v_add_f32 v49, v49, v118
    v_add_f32 v51, v51, v126
    v_add_f32 v49, v49, v51
    s_nop 1
    v_permlane32_swap_b32 v48, v49
    v_add_f32 v48, v48, v49
    v_mov_b32 v49, v48
    s_nop 1
    v_permlane32_swap_b32 v48, v49
    v_rcp_f32 v51, v49
    v_mul_f32 v41, 0x358637bd, v48
    v_mul_f32 v51, v51, v48
    v_cvt_pk_bf16_f32 v96, v96, v97
    v_cvt_pk_bf16_f32 v97, v98, v99
    v_lshrrev_b32 v16, 5, v1
    v_lshlrev_b32 v16, 12, v16
    v_and_b32 v17, 31, v1
    v_lshl_add_u32 v16, v17, 4, v16
    s_lshl_b32 s74, s52, 15
    s_lshr_b32 s57, s48, 1
    s_lshl_b32 s57, s57, 10
    s_add_u32 s74, s74, s57
    s_and_b32 s57, s48, 1
    s_lshl_b32 s57, s57, 9
    s_add_u32 s74, s74, s57
    s_add_u32 s74, s74, 10485760
    s_add_u32 s57, s74, 0
    buffer_load_dwordx4 v[224:227], v16, s[16:19], s57 offen sc1
    s_add_u32 s57, s74, 8192
    buffer_load_dwordx4 v[228:231], v16, s[16:19], s57 offen sc1
    s_add_u32 s57, s74, 16384
    buffer_load_dwordx4 v[232:235], v16, s[16:19], s57 offen sc1
    s_add_u32 s57, s74, 24576
    buffer_load_dwordx4 v[236:239], v16, s[16:19], s57 offen sc1
    s_waitcnt vmcnt(8)
    v_cmp_ne_u64 s[82:83], v[6:7], v[10:11]
    s_nop 0
    s_cmp_eq_u64 s[82:83], 0
    s_cbranch_scc0 L_ps_18
L_pb_19:
    v_cvt_pk_bf16_f32 v98, v100, v101
    s_add_u32 s65, s5, 0
    buffer_load_dwordx4 v[128:131], v5, s[16:19], s65 offen offset:0 sc1
    v_cvt_pk_bf16_f32 v99, v102, 0
    v_cvt_pk_bf16_f32 v100, v104, v105
    s_add_u32 s65, s5, 0
    buffer_load_dwordx4 v[132:135], v5, s[16:19], s65 offen offset:1024 sc1
    v_cvt_pk_bf16_f32 v101, v106, v107
    s_add_u32 s65, s5, 0
    buffer_load_dwordx4 v[136:139], v5, s[16:19], s65 offen offset:2048 sc1
    v_cvt_pk_bf16_f32 v102, v108, v109
    v_cvt_pk_bf16_f32 v103, v110, 0
    s_add_u32 s65, s5, 0
    buffer_load_dwordx4 v[140:143], v5, s[16:19], s65 offen offset:3072 sc1
    v_mul_f32 v112, v112, v51
    v_mul_f32 v113, v113, v51
    s_add_u32 s65, s5, 4096
    buffer_load_dwordx4 v[144:147], v5, s[16:19], s65 offen offset:0 sc1
    v_mul_f32 v114, v114, v51
    s_add_u32 s65, s5, 4096
    buffer_load_dwordx4 v[148:151], v5, s[16:19], s65 offen offset:1024 sc1
    v_mul_f32 v115, v115, v51
    v_mul_f32 v116, v116, v51
    s_add_u32 s65, s5, 4096
    buffer_load_dwordx4 v[152:155], v5, s[16:19], s65 offen offset:2048 sc1
    v_mul_f32 v117, v117, v51
    v_mul_f32 v118, v118, v51
    s_add_u32 s65, s5, 4096
    buffer_load_dwordx4 v[156:159], v5, s[16:19], s65 offen offset:3072 sc1
    v_mul_f32 v120, v120, v51
    s_add_u32 s65, s5, 16384
    buffer_load_dwordx4 v[160:163], v5, s[16:19], s65 offen offset:0 sc1
    v_mul_f32 v121, v121, v51
    v_mul_f32 v122, v122, v51
    s_add_u32 s65, s5, 16384
    buffer_load_dwordx4 v[164:167], v5, s[16:19], s65 offen offset:1024 sc1
    v_mul_f32 v123, v123, v51
    v_mul_f32 v124, v124, v51
    s_add_u32 s65, s5, 16384
    buffer_load_dwordx4 v[168:171], v5, s[16:19], s65 offen offset:2048 sc1
    v_mul_f32 v125, v125, v51
    s_add_u32 s65, s5, 16384
    buffer_load_dwordx4 v[172:175], v5, s[16:19], s65 offen offset:3072 sc1
    v_mul_f32 v126, v126, v51
    v_cvt_pk_bf16_f32 v112, v112, v113
    s_add_u32 s65, s5, 20480
    buffer_load_dwordx4 v[176:179], v5, s[16:19], s65 offen offset:0 sc1
    v_cvt_pk_bf16_f32 v113, v114, v115
    v_cvt_pk_bf16_f32 v114, v116, v117
    s_add_u32 s65, s5, 20480
    buffer_load_dwordx4 v[180:183], v5, s[16:19], s65 offen offset:1024 sc1
    v_cvt_pk_bf16_f32 v115, v118, 0
    s_add_u32 s65, s5, 20480
    buffer_load_dwordx4 v[184:187], v5, s[16:19], s65 offen offset:2048 sc1
    v_cvt_pk_bf16_f32 v116, v120, v121
    v_cvt_pk_bf16_f32 v117, v122, v123
    s_add_u32 s65, s5, 20480
    buffer_load_dwordx4 v[188:191], v5, s[16:19], s65 offen offset:3072 sc1
    v_cvt_pk_bf16_f32 v118, v124, v125
    v_cvt_pk_bf16_f32 v119, v126, 0
    s_waitcnt vmcnt(19)
    v_xor_b32 v53, v8, v227
    s_waitcnt vmcnt(18)
    v_xor_b32 v54, v8, v231
    v_or_b32 v53, v53, v54
    s_waitcnt vmcnt(17)
    v_xor_b32 v54, v8, v235
    v_or_b32 v53, v53, v54
    s_waitcnt vmcnt(16)
    v_xor_b32 v54, v8, v239
    v_or_b32 v53, v53, v54
    v_cmp_lt_u32 vcc, 0xffff, v53
    s_cbranch_vccnz L_gs_21
L_gb_22:
    v_lshlrev_b32 v64, 16, v224
    v_and_b32 v65, 0xffff0000, v224
    v_lshlrev_b32 v66, 16, v225
    v_and_b32 v67, 0xffff0000, v225
    v_lshlrev_b32 v68, 16, v226
    v_and_b32 v69, 0xffff0000, v226
    v_lshlrev_b32 v70, 16, v227
    v_lshlrev_b32 v53, 16, v228
    v_add_f32 v64, v64, v53
    v_and_b32 v54, 0xffff0000, v228
    v_add_f32 v65, v65, v54
    v_lshlrev_b32 v53, 16, v229
    v_add_f32 v66, v66, v53
    v_and_b32 v54, 0xffff0000, v229
    v_add_f32 v67, v67, v54
    v_lshlrev_b32 v53, 16, v230
    v_add_f32 v68, v68, v53
    v_and_b32 v54, 0xffff0000, v230
    v_add_f32 v69, v69, v54
    v_lshlrev_b32 v53, 16, v231
    v_add_f32 v70, v70, v53
    v_lshlrev_b32 v53, 16, v232
    v_add_f32 v64, v64, v53
    v_and_b32 v54, 0xffff0000, v232
    v_add_f32 v65, v65, v54
    v_lshlrev_b32 v53, 16, v233
    v_add_f32 v66, v66, v53
    v_and_b32 v54, 0xffff0000, v233
    v_add_f32 v67, v67, v54
    v_lshlrev_b32 v53, 16, v234
    v_add_f32 v68, v68, v53
    v_and_b32 v54, 0xffff0000, v234
    v_add_f32 v69, v69, v54
    v_lshlrev_b32 v53, 16, v235
    v_add_f32 v70, v70, v53
    v_lshlrev_b32 v53, 16, v236
    v_add_f32 v64, v64, v53
    v_and_b32 v54, 0xffff0000, v236
    v_add_f32 v65, v65, v54
    v_lshlrev_b32 v53, 16, v237
    v_add_f32 v66, v66, v53
    v_and_b32 v54, 0xffff0000, v237
    v_add_f32 v67, v67, v54
    v_lshlrev_b32 v53, 16, v238
    v_add_f32 v68, v68, v53
    v_and_b32 v54, 0xffff0000, v238
    v_add_f32 v69, v69, v54
    v_lshlrev_b32 v53, 16, v239
    v_add_f32 v70, v70, v53
    v_mov_b32 v71, 0
    v_permlane32_swap_b32 v64, v68
    v_permlane32_swap_b32 v65, v69
    v_permlane32_swap_b32 v66, v70
    v_permlane32_swap_b32 v67, v71
    v_add_f32 v64, v64, v68
    v_add_f32 v65, v65, v69
    v_add_f32 v66, v66, v70
    v_add_f32 v67, v67, v71
    v_cvt_pk_bf16_f32 v64, v64, v65
    v_cvt_pk_bf16_f32 v65, v66, v67
    v_and_b32 v53, 31, v1
    v_lshlrev_b32 v53, 4, v53
    v_lshrrev_b32 v54, 5, v1
    v_lshl_add_u32 v53, v54, 3, v53
    s_lshr_b32 s57, s48, 1
    s_lshl_b32 s57, s57, 10
    s_and_b32 s58, s48, 1
    s_lshl_b32 s58, s58, 9
    s_add_u32 s57, s57, s58
    s_add_u32 s57, s57, 53248
    v_add_u32 v53, s57, v53
    ds_write_b64 v53, v[64:65]
    s_waitcnt lgkmcnt(0)
    s_barrier
    ds_read_b128 v[80:83], v18 offset:0
    ds_read_b128 v[84:87], v18 offset:1024
    ds_read_b128 v[88:91], v18 offset:2048
    ds_read_b128 v[92:95], v18 offset:3072
    s_waitcnt lgkmcnt(3)
    v_mfma_f32_32x32x16_bf16 v[64:79], v[80:83], v[96:99], 0
    s_waitcnt lgkmcnt(2)
    v_mfma_f32_32x32x16_bf16 v[64:79], v[84:87], v[100:103], v[64:79]
    s_waitcnt lgkmcnt(1)
    v_mfma_f32_32x32x16_bf16 v[64:79], v[88:91], v[112:115], v[64:79]
    s_waitcnt lgkmcnt(0)
    v_mfma_f32_32x32x16_bf16 v[64:79], v[92:95], v[116:119], v[64:79]
    s_lshr_b32 s57, s71, 5
    s_mul_i32 s57, s57, 144
    s_lshl_b32 s58, s52, 1
    s_add_u32 s57, s57, s58
    s_add_u32 s57, s57, 112
    s_lshl_b32 s60, s57, 10
    s_nop 5
    v_add_f32 v49, v71, v41
    v_rcp_f32 v49, v49
    s_nop 0
    v_mul_f32 v49, 0x3fb8aa3b, v49
    v_mul_f32 v64, v64, v49
    v_mul_f32 v65, v65, v49
    v_mul_f32 v66, v66, v49
    v_mul_f32 v67, v67, v49
    v_mul_f32 v68, v68, v49
    v_mul_f32 v69, v69, v49
    v_mul_f32 v70, v70, v49
    v_mul_f32 v72, v72, v49
    v_mul_f32 v73, v73, v49
    v_mul_f32 v74, v74, v49
    v_mul_f32 v75, v75, v49
    v_mul_f32 v76, v76, v49
    v_mul_f32 v77, v77, v49
    v_mul_f32 v78, v78, v49
    v_cvt_pk_bf16_f32 v64, v64, v65
    v_cvt_pk_bf16_f32 v65, v66, v67
    v_cvt_pk_bf16_f32 v66, v68, v69
    v_cvt_pk_bf16_f32 v67, v70, 0
    v_cvt_pk_bf16_f32 v68, v72, v73
    v_cvt_pk_bf16_f32 v69, v74, v75
    v_cvt_pk_bf16_f32 v70, v76, v77
    v_cvt_pk_bf16_f32 v71, v78, 0
    v_or_b32 v67, v8, v67
    v_or_b32 v71, v8, v71
    buffer_store_dwordx4 v[64:67], v5, s[16:19], s60 offen offset:0 sc1
    buffer_store_dwordx4 v[68:71], v5, s[16:19], s60 offen offset:1024 sc1
    s_barrier
    s_add_u32 s57, s3, 114688
    s_add_u32 m0, s76, 32768
    s_nop 0
    buffer_load_dwordx4 v2, s[24:27], s57 offen offset:0 lds
    buffer_load_dwordx4 v44, s[24:27], s57 offen offset:1024 lds
    buffer_load_dwordx4 v45, s[24:27], s57 offen offset:2048 lds
    buffer_load_dwordx4 v46, s[24:27], s57 offen offset:3072 lds
    s_cmp_ge_u32 s79, 12
    s_nop 1
    s_cbranch_scc1 L_fin
    v_lshrrev_b32 v48, 5, v1
    v_bfe_u32 v49, v1, 2, 2
    v_lshl_add_u32 v48, v48, 2, v49
    v_lshlrev_b32 v48, 7, v48
    v_bfe_u32 v50, v1, 4, 1
    v_lshlrev_b32 v50, 5, v50
    v_and_b32 v51, 3, v1
    v_lshl_add_u32 v50, v51, 3, v50
    v_lshrrev_b32 v49, 1, v49
    v_lshlrev_b32 v49, 6, v49
    v_xor_b32 v50, v50, v49
    v_add_u32 v48, v48, v50
    v_add_u32 v12, s76, v48
    v_and_b32 v12, 0xffffefff, v12
    v_xor_b32 v13, 64, v12
    v_add_u32 v14, 0x10000, v12
    v_add_u32 v15, 0x10000, v13
    v_add_u32 v16, 0x20000, v12
    v_add_u32 v17, 0x20000, v13
    v_and_b32 v48, 31, v1
    v_mul_u32_u24 v48, 896, v48
    v_lshrrev_b32 v49, 5, v1
    v_lshl_add_u32 v18, v49, 4, v48
    buffer_load_dwordx4 v[20:23], v18, s[8:11], s7 offen
    s_mov_b32 s75, 0x3f317218
    buffer_load_dwordx2 v[54:55], v9, s[16:19], s77 offen offset:128 sc1
    s_nop 1
    s_barrier
    ds_read_b64_tr_b16 v[56:57], v16 offset:0
    ds_read_b64_tr_b16 v[58:59], v16 offset:1024
    ds_read_b64_tr_b16 v[60:61], v17 offset:0
    ds_read_b64_tr_b16 v[62:63], v17 offset:1024
    ds_read_b64_tr_b16 v[240:241], v16 offset:2048
    ds_read_b64_tr_b16 v[242:243], v16 offset:3072
    ds_read_b64_tr_b16 v[244:245], v17 offset:2048
    ds_read_b64_tr_b16 v[246:247], v17 offset:3072
    s_waitcnt vmcnt(23) lgkmcnt(4)
    v_mfma_f32_32x32x16_bf16 v[64:79], v[56:59], v[128:131], 0
    ds_read_b64_tr_b16 v[248:249], v16 offset:4096
    ds_read_b64_tr_b16 v[250:251], v16 offset:5120
    v_mfma_f32_32x32x16_bf16 v[80:95], v[60:63], v[128:131], 0
    ds_read_b64_tr_b16 v[252:253], v17 offset:4096
    ds_read_b64_tr_b16 v[254:255], v17 offset:5120
    s_lshr_b32 s57, s48, 2
    s_lshl_b32 s57, s57, 15
    s_add_u32 s57, s57, 98304
    s_and_b32 s60, s48, 3
    s_lshl_b32 s59, s60, 11
    s_add_u32 s59, s59, s57
    v_add_u32 v0, s59, v5
    s_lshl_b32 s59, s60, 13
    s_add_u32 s59, s59, s57
    v_add_u32 v4, s59, v5
    s_waitcnt vmcnt(22) lgkmcnt(4)
    v_mfma_f32_32x32x16_bf16 v[64:79], v[240:243], v[132:135], v[64:79]
    ds_read_b64_tr_b16 v[56:57], v16 offset:6144
    ds_read_b64_tr_b16 v[58:59], v16 offset:7168
    v_mfma_f32_32x32x16_bf16 v[80:95], v[244:247], v[132:135], v[80:95]
    ds_read_b64_tr_b16 v[60:61], v17 offset:6144
    ds_read_b64_tr_b16 v[62:63], v17 offset:7168
    s_waitcnt vmcnt(21) lgkmcnt(4)
    v_mfma_f32_32x32x16_bf16 v[64:79], v[248:251], v[136:139], v[64:79]
    ds_read_b64_tr_b16 v[240:241], v14 offset:32768
    ds_read_b64_tr_b16 v[242:243], v14 offset:33792
    v_mfma_f32_32x32x16_bf16 v[80:95], v[252:255], v[136:139], v[80:95]
    ds_read_b64_tr_b16 v[244:245], v15 offset:32768
    ds_read_b64_tr_b16 v[246:247], v15 offset:33792
    s_waitcnt vmcnt(0)
    v_cmp_ne_u64 s[82:83], v[6:7], v[54:55]
    s_nop 0
    s_cmp_eq_u64 s[82:83], 0
    s_cbranch_scc0 L_ps_24
L_pb_25:
    s_waitcnt lgkmcnt(4)
    v_mfma_f32_32x32x16_bf16 v[64:79], v[56:59], v[140:143], v[64:79]
    ds_read_b64_tr_b16 v[248:249], v14 offset:34816
    ds_read_b64_tr_b16 v[250:251], v14 offset:35840
    v_mfma_f32_32x32x16_bf16 v[80:95], v[60:63], v[140:143], v[80:95]
    ds_read_b64_tr_b16 v[252:253], v15 offset:34816
    ds_read_b64_tr_b16 v[254:255], v15 offset:35840
    s_barrier
    s_waitcnt lgkmcnt(4)
    v_mfma_f32_32x32x16_bf16 v[64:79], v[240:243], v[144:147], v[64:79]
    ds_read_b64_tr_b16 v[56:57], v14 offset:36864
    ds_read_b64_tr_b16 v[58:59], v14 offset:37888
    v_mfma_f32_32x32x16_bf16 v[80:95], v[244:247], v[144:147], v[80:95]
    ds_read_b64_tr_b16 v[60:61], v15 offset:36864
    ds_read_b64_tr_b16 v[62:63], v15 offset:37888
    s_add_u32 s58, s76, 131072
    v_add_u32 v52, s58, v5
    ds_write_b128 v52, v[192:195] offset:0
    ds_write_b128 v52, v[196:199] offset:1024
    s_waitcnt lgkmcnt(6)
    v_mfma_f32_32x32x16_bf16 v[64:79], v[248:251], v[148:151], v[64:79]
    ds_read_b64_tr_b16 v[240:241], v14 offset:38912
    ds_read_b64_tr_b16 v[242:243], v14 offset:39936
    ds_write_b128 v52, v[200:203] offset:2048
    ds_write_b128 v52, v[204:207] offset:3072
    v_add_u32 v44, 6144, v3
    v_add_u32 v45, 10496, v2
    v_add_u32 v46, 16640, v3
    v_mfma_f32_32x32x16_bf16 v[80:95], v[252:255], v[148:151], v[80:95]
    ds_read_b64_tr_b16 v[244:245], v15 offset:38912
    ds_read_b64_tr_b16 v[246:247], v15 offset:39936
    s_add_u32 s59, s5, 8192
    buffer_load_dwordx4 v[192:195], v5, s[16:19], s59 offen offset:0 sc1
    s_waitcnt lgkmcnt(8)
    v_mfma_f32_32x32x16_bf16 v[64:79], v[56:59], v[152:155], v[64:79]
    ds_read_b64_tr_b16 v[248:249], v14 offset:0
    ds_read_b64_tr_b16 v[250:251], v14 offset:1024
    buffer_load_dwordx4 v[196:199], v5, s[16:19], s59 offen offset:1024 sc1
    v_mfma_f32_32x32x16_bf16 v[80:95], v[60:63], v[152:155], v[80:95]
    ds_read_b64_tr_b16 v[252:253], v15 offset:0
    ds_read_b64_tr_b16 v[254:255], v15 offset:1024
    buffer_load_dwordx4 v[200:203], v5, s[16:19], s59 offen offset:2048 sc1
    s_waitcnt lgkmcnt(4)
    v_mfma_f32_32x32x16_bf16 v[64:79], v[240:243], v[156:159], v[64:79]
    ds_read_b64_tr_b16 v[56:57], v14 offset:2048
    ds_read_b64_tr_b16 v[58:59], v14 offset:3072
    buffer_load_dwordx4 v[204:207], v5, s[16:19], s59 offen offset:3072 sc1
    v_mfma_f32_32x32x16_bf16 v[80:95], v[244:247], v[156:159], v[80:95]
    ds_read_b64_tr_b16 v[60:61], v15 offset:2048
    ds_read_b64_tr_b16 v[62:63], v15 offset:3072
    s_barrier
    s_waitcnt lgkmcnt(4)
    v_mfma_f32_32x32x16_bf16 v[64:79], v[248:251], v[160:163], v[64:79]
    ds_read_b64_tr_b16 v[240:241], v14 offset:4096
    ds_read_b64_tr_b16 v[242:243], v14 offset:5120
    v_mfma_f32_32x32x16_bf16 v[80:95], v[252:255], v[160:163], v[80:95]
    ds_read_b64_tr_b16 v[244:245], v15 offset:4096
    ds_read_b64_tr_b16 v[246:247], v15 offset:5120
    s_add_u32 s58, s76, 98304
    v_add_u32 v53, s58, v5
    ds_write_b128 v53, v[208:211] offset:0
    ds_write_b128 v53, v[212:215] offset:1024
    s_waitcnt lgkmcnt(6)
    v_mfma_f32_32x32x16_bf16 v[64:79], v[56:59], v[164:167], v[64:79]
    ds_read_b64_tr_b16 v[248:249], v14 offset:6144
    ds_read_b64_tr_b16 v[250:251], v14 offset:7168
    ds_write_b128 v53, v[216:219] offset:2048
    ds_write_b128 v53, v[220:223] offset:3072
    v_mfma_f32_32x32x16_bf16 v[80:95], v[60:63], v[164:167], v[80:95]
    ds_read_b64_tr_b16 v[252:253], v15 offset:6144
    ds_read_b64_tr_b16 v[254:255], v15 offset:7168
    s_add_u32 s59, s5, 12288
    buffer_load_dwordx4 v[208:211], v5, s[16:19], s59 offen offset:0 sc1
    s_waitcnt lgkmcnt(8)
    v_mfma_f32_32x32x16_bf16 v[64:79], v[240:243], v[168:171], v[64:79]
    ds_read_b64_tr_b16 v[56:57], v12 offset:0
    ds_read_b64_tr_b16 v[58:59], v12 offset:1024
    buffer_load_dwordx4 v[212:215], v5, s[16:19], s59 offen offset:1024 sc1
    v_mfma_f32_32x32x16_bf16 v[80:95], v[244:247], v[168:171], v[80:95]
    ds_read_b64_tr_b16 v[60:61], v13 offset:0
    ds_read_b64_tr_b16 v[62:63], v13 offset:1024
    buffer_load_dwordx4 v[216:219], v5, s[16:19], s59 offen offset:2048 sc1
    s_waitcnt lgkmcnt(4)
    v_mfma_f32_32x32x16_bf16 v[64:79], v[248:251], v[172:175], v[64:79]
    ds_read_b64_tr_b16 v[240:241], v12 offset:2048
    ds_read_b64_tr_b16 v[242:243], v12 offset:3072
    buffer_load_dwordx4 v[220:223], v5, s[16:19], s59 offen offset:3072 sc1
    v_mfma_f32_32x32x16_bf16 v[80:95], v[252:255], v[172:175], v[80:95]
    ds_read_b64_tr_b16 v[244:245], v13 offset:2048
    ds_read_b64_tr_b16 v[246:247], v13 offset:3072
    s_barrier
    s_add_u32 s58, s4, 0
    s_add_u32 m0, s76, 65536
    s_add_u32 s59, s5, 24576
    buffer_load_dwordx4 v[224:227], v5, s[16:19], s59 offen offset:0 sc1
    s_waitcnt lgkmcnt(4)
    v_mfma_f32_32x32x16_bf16 v[64:79], v[56:59], v[176:179], v[64:79]
    ds_read_b64_tr_b16 v[248:249], v12 offset:4096
    ds_read_b64_tr_b16 v[250:251], v12 offset:5120
    buffer_load_dwordx4 v2, s[28:31], s58 offen offset:0 lds
    buffer_load_dwordx4 v44, s[28:31], s58 offen offset:1024 lds
    buffer_load_dwordx4 v[228:231], v5, s[16:19], s59 offen offset:1024 sc1
    v_mfma_f32_32x32x16_bf16 v[80:95], v[60:63], v[176:179], v[80:95]
    ds_read_b64_tr_b16 v[252:253], v13 offset:4096
    ds_read_b64_tr_b16 v[254:255], v13 offset:5120
    buffer_load_dwordx4 v45, s[28:31], s58 offen offset:2048 lds
    buffer_load_dwordx4 v46, s[28:31], s58 offen offset:3072 lds
    buffer_load_dwordx4 v[232:235], v5, s[16:19], s59 offen offset:2048 sc1
    s_waitcnt lgkmcnt(4)
    v_mfma_f32_32x32x16_bf16 v[64:79], v[240:243], v[180:183], v[64:79]
    ds_read_b64_tr_b16 v[56:57], v12 offset:6144
    ds_read_b64_tr_b16 v[58:59], v12 offset:7168
    buffer_load_dwordx4 v[236:239], v5, s[16:19], s59 offen offset:3072 sc1
    v_mfma_f32_32x32x16_bf16 v[80:95], v[244:247], v[180:183], v[80:95]
    ds_read_b64_tr_b16 v[60:61], v13 offset:6144
    ds_read_b64_tr_b16 v[62:63], v13 offset:7168
    s_waitcnt lgkmcnt(4)
    v_mfma_f32_32x32x16_bf16 v[64:79], v[248:251], v[184:187], v[64:79]
    ds_read_b64_tr_b16 v[240:241], v12 offset:32768
    ds_read_b64_tr_b16 v[242:243], v12 offset:33792
    v_mfma_f32_32x32x16_bf16 v[80:95], v[252:255], v[184:187], v[80:95]
    ds_read_b64_tr_b16 v[244:245], v13 offset:32768
    ds_read_b64_tr_b16 v[246:247], v13 offset:33792
    s_waitcnt lgkmcnt(4)
    v_mfma_f32_32x32x16_bf16 v[64:79], v[56:59], v[188:191], v[64:79]
    ds_read_b64_tr_b16 v[248:249], v12 offset:34816
    ds_read_b64_tr_b16 v[250:251], v12 offset:35840
    v_mfma_f32_32x32x16_bf16 v[80:95], v[60:63], v[188:191], v[80:95]
    ds_read_b64_tr_b16 v[252:253], v13 offset:34816
    ds_read_b64_tr_b16 v[254:255], v13 offset:35840
    s_barrier
    s_add_u32 s58, s4, 50176
    s_add_u32 m0, s76, 0
    s_waitcnt vmcnt(15) lgkmcnt(4)
    v_mfma_f32_32x32x16_bf16 v[64:79], v[240:243], v[192:195], v[64:79]
    ds_read_b64_tr_b16 v[56:57], v12 offset:36864
    ds_read_b64_tr_b16 v[58:59], v12 offset:37888
    buffer_load_dwordx4 v2, s[28:31], s58 offen offset:0 lds
    buffer_load_dwordx4 v44, s[28:31], s58 offen offset:1024 lds
    v_mfma_f32_32x32x16_bf16 v[80:95], v[244:247], v[192:195], v[80:95]
    ds_read_b64_tr_b16 v[60:61], v13 offset:36864
    ds_read_b64_tr_b16 v[62:63], v13 offset:37888
    buffer_load_dwordx4 v45, s[28:31], s58 offen offset:2048 lds
    buffer_load_dwordx4 v46, s[28:31], s58 offen offset:3072 lds
    s_waitcnt vmcnt(18) lgkmcnt(4)
    v_mfma_f32_32x32x16_bf16 v[64:79], v[248:251], v[196:199], v[64:79]
    ds_read_b64_tr_b16 v[240:241], v12 offset:38912
    ds_read_b64_tr_b16 v[242:243], v12 offset:39936
    s_add_u32 s59, s6, 0
    buffer_load_dwordx4 v[96:99], v5, s[16:19], s59 offen offset:0 sc1
    v_mfma_f32_32x32x16_bf16 v[80:95], v[252:255], v[196:199], v[80:95]
    ds_read_b64_tr_b16 v[244:245], v13 offset:38912
    ds_read_b64_tr_b16 v[246:247], v13 offset:39936
    buffer_load_dwordx4 v[100:103], v5, s[16:19], s59 offen offset:1024 sc1
    s_waitcnt vmcnt(19) lgkmcnt(4)
    v_mfma_f32_32x32x16_bf16 v[64:79], v[56:59], v[200:203], v[64:79]
    ds_read_b64_tr_b16 v[248:249], v16 offset:0
    ds_read_b64_tr_b16 v[250:251], v16 offset:1024
    buffer_load_dwordx4 v[104:107], v5, s[16:19], s59 offen offset:2048 sc1
    v_mfma_f32_32x32x16_bf16 v[80:95], v[60:63], v[200:203], v[80:95]
    ds_read_b64_tr_b16 v[252:253], v17 offset:0
    ds_read_b64_tr_b16 v[254:255], v17 offset:1024
    buffer_load_dwordx4 v[108:111], v5, s[16:19], s59 offen offset:3072 sc1
    s_waitcnt vmcnt(20) lgkmcnt(4)
    v_mfma_f32_32x32x16_bf16 v[64:79], v[240:243], v[204:207], v[64:79]
    ds_read_b64_tr_b16 v[56:57], v16 offset:2048
    ds_read_b64_tr_b16 v[58:59], v16 offset:3072
    s_add_u32 s59, s6, 4096
    buffer_load_dwordx4 v[112:115], v5, s[16:19], s59 offen offset:0 sc1
    v_mfma_f32_32x32x16_bf16 v[80:95], v[244:247], v[204:207], v[80:95]
    ds_read_b64_tr_b16 v[60:61], v17 offset:2048
    ds_read_b64_tr_b16 v[62:63], v17 offset:3072
    s_barrier
    buffer_load_dwordx4 v[116:119], v5, s[16:19], s59 offen offset:1024 sc1
    s_waitcnt vmcnt(21) lgkmcnt(4)
    v_mfma_f32_32x32x16_bf16 v[64:79], v[248:251], v[208:211], v[64:79]
    ds_read_b64_tr_b16 v[240:241], v16 offset:4096
    ds_read_b64_tr_b16 v[242:243], v16 offset:5120
    buffer_load_dwordx4 v[120:123], v5, s[16:19], s59 offen offset:2048 sc1
    v_mfma_f32_32x32x16_bf16 v[80:95], v[252:255], v[208:211], v[80:95]
    ds_read_b64_tr_b16 v[244:245], v17 offset:4096
    ds_read_b64_tr_b16 v[246:247], v17 offset:5120
    buffer_load_dwordx4 v[124:127], v5, s[16:19], s59 offen offset:3072 sc1
    s_waitcnt vmcnt(22) lgkmcnt(4)
    v_mfma_f32_32x32x16_bf16 v[64:79], v[56:59], v[212:215], v[64:79]
    ds_read_b64_tr_b16 v[248:249], v16 offset:6144
    ds_read_b64_tr_b16 v[250:251], v16 offset:7168
    v_mfma_f32_32x32x16_bf16 v[80:95], v[60:63], v[212:215], v[80:95]
    ds_read_b64_tr_b16 v[252:253], v17 offset:6144
    ds_read_b64_tr_b16 v[254:255], v17 offset:7168
    s_waitcnt vmcnt(21) lgkmcnt(4)
    v_mfma_f32_32x32x16_bf16 v[64:79], v[240:243], v[216:219], v[64:79]
    ds_read_b64_tr_b16 v[56:57], v14 offset:32768
    ds_read_b64_tr_b16 v[58:59], v14 offset:33792
    v_mfma_f32_32x32x16_bf16 v[80:95], v[244:247], v[216:219], v[80:95]
    ds_read_b64_tr_b16 v[60:61], v15 offset:32768
    ds_read_b64_tr_b16 v[62:63], v15 offset:33792
    s_waitcnt vmcnt(20) lgkmcnt(4)
    v_mfma_f32_32x32x16_bf16 v[64:79], v[248:251], v[220:223], v[64:79]
    ds_read_b64_tr_b16 v[240:241], v14 offset:34816
    ds_read_b64_tr_b16 v[242:243], v14 offset:35840
    v_mfma_f32_32x32x16_bf16 v[80:95], v[252:255], v[220:223], v[80:95]
    ds_read_b64_tr_b16 v[244:245], v15 offset:34816
    ds_read_b64_tr_b16 v[246:247], v15 offset:35840
    s_waitcnt vmcnt(14)
    s_barrier
    s_waitcnt lgkmcnt(4)
    v_mfma_f32_32x32x16_bf16 v[64:79], v[56:59], v[224:227], v[64:79]
    ds_read_b64_tr_b16 v[248:249], v14 offset:36864
    ds_read_b64_tr_b16 v[250:251], v14 offset:37888
    v_mfma_f32_32x32x16_bf16 v[80:95], v[60:63], v[224:227], v[80:95]
    ds_read_b64_tr_b16 v[252:253], v15 offset:36864
    ds_read_b64_tr_b16 v[254:255], v15 offset:37888
    s_waitcnt lgkmcnt(4)
    v_mfma_f32_32x32x16_bf16 v[64:79], v[240:243], v[228:231], v[64:79]
    ds_read_b64_tr_b16 v[56:57], v14 offset:38912
    ds_read_b64_tr_b16 v[58:59], v14 offset:39936
    v_mfma_f32_32x32x16_bf16 v[80:95], v[244:247], v[228:231], v[80:95]
    ds_read_b64_tr_b16 v[60:61], v15 offset:38912
    ds_read_b64_tr_b16 v[62:63], v15 offset:39936
    s_waitcnt vmcnt(13) lgkmcnt(4)
    v_mfma_f32_32x32x16_bf16 v[64:79], v[248:251], v[232:235], v[64:79]
    ds_read_b64_tr_b16 v[240:241], v14 offset:0
    ds_read_b64_tr_b16 v[242:243], v14 offset:1024
    v_mfma_f32_32x32x16_bf16 v[80:95], v[252:255], v[232:235], v[80:95]
    ds_read_b64_tr_b16 v[244:245], v15 offset:0
    ds_read_b64_tr_b16 v[246:247], v15 offset:1024
    s_waitcnt vmcnt(7)
    v_xor_b32 v48, v8, v99
    s_waitcnt vmcnt(6)
    v_xor_b32 v49, v8, v103
    v_or_b32 v48, v48, v49
    s_waitcnt vmcnt(5)
    v_xor_b32 v49, v8, v107
    v_or_b32 v48, v48, v49
    s_waitcnt vmcnt(4)
    v_xor_b32 v49, v8, v111
    v_or_b32 v48, v48, v49
    v_cmp_lt_u32 vcc, 0xffff, v48
    s_cbranch_vccnz L_os_27
L_ob_28:
    v_and_b32 v99, 0xffff, v99
    v_and_b32 v103, 0xffff, v103
    v_and_b32 v107, 0xffff, v107
    v_and_b32 v111, 0xffff, v111
    s_waitcnt lgkmcnt(4)
    v_mfma_f32_32x32x16_bf16 v[64:79], v[56:59], v[236:239], v[64:79]
    ds_read_b64_tr_b16 v[248:249], v14 offset:2048
    ds_read_b64_tr_b16 v[250:251], v14 offset:3072
    v_mfma_f32_32x32x16_bf16 v[80:95], v[60:63], v[236:239], v[80:95]
    ds_read_b64_tr_b16 v[252:253], v15 offset:2048
    ds_read_b64_tr_b16 v[254:255], v15 offset:3072
    s_barrier
    s_waitcnt lgkmcnt(4)
    v_mfma_f32_32x32x16_bf16 v[64:79], v[240:243], v[96:99], v[64:79]
    ds_read_b64_tr_b16 v[56:57], v14 offset:4096
    ds_read_b64_tr_b16 v[58:59], v14 offset:5120
    v_mfma_f32_32x32x16_bf16 v[80:95], v[244:247], v[96:99], v[80:95]
    ds_read_b64_tr_b16 v[60:61], v15 offset:4096
    ds_read_b64_tr_b16 v[62:63], v15 offset:5120
    s_waitcnt lgkmcnt(4)
    v_mfma_f32_32x32x16_bf16 v[64:79], v[248:251], v[100:103], v[64:79]
    ds_read_b64_tr_b16 v[240:241], v14 offset:6144
    ds_read_b64_tr_b16 v[242:243], v14 offset:7168
    v_mfma_f32_32x32x16_bf16 v[80:95], v[252:255], v[100:103], v[80:95]
    ds_read_b64_tr_b16 v[244:245], v15 offset:6144
    ds_read_b64_tr_b16 v[246:247], v15 offset:7168
    s_waitcnt lgkmcnt(4)
    v_mfma_f32_32x32x16_bf16 v[64:79], v[56:59], v[104:107], v[64:79]
    ds_read_b64_tr_b16 v[248:249], v12 offset:0
    ds_read_b64_tr_b16 v[250:251], v12 offset:1024
    v_mfma_f32_32x32x16_bf16 v[80:95], v[60:63], v[104:107], v[80:95]
    ds_read_b64_tr_b16 v[252:253], v13 offset:0
    ds_read_b64_tr_b16 v[254:255], v13 offset:1024
    s_waitcnt vmcnt(3)
    v_xor_b32 v48, v8, v115
    s_waitcnt vmcnt(2)
    v_xor_b32 v49, v8, v119
    v_or_b32 v48, v48, v49
    s_waitcnt vmcnt(1)
    v_xor_b32 v49, v8, v123
    v_or_b32 v48, v48, v49
    s_waitcnt vmcnt(0)
    v_xor_b32 v49, v8, v127
    v_or_b32 v48, v48, v49
    v_cmp_lt_u32 vcc, 0xffff, v48
    s_cbranch_vccnz L_os_30
L_ob_31:
    v_and_b32 v115, 0xffff, v115
    v_and_b32 v119, 0xffff, v119
    v_and_b32 v123, 0xffff, v123
    v_and_b32 v127, 0xffff, v127
    s_waitcnt lgkmcnt(4)
    v_mfma_f32_32x32x16_bf16 v[64:79], v[240:243], v[108:111], v[64:79]
    ds_read_b64_tr_b16 v[56:57], v12 offset:2048
    ds_read_b64_tr_b16 v[58:59], v12 offset:3072
    v_mfma_f32_32x32x16_bf16 v[80:95], v[244:247], v[108:111], v[80:95]
    ds_read_b64_tr_b16 v[60:61], v13 offset:2048
    ds_read_b64_tr_b16 v[62:63], v13 offset:3072
    s_waitcnt lgkmcnt(4)
    v_mfma_f32_32x32x16_bf16 v[64:79], v[248:251], v[112:115], v[64:79]
    ds_read_b64_tr_b16 v[240:241], v12 offset:4096
    ds_read_b64_tr_b16 v[242:243], v12 offset:5120
    v_mfma_f32_32x32x16_bf16 v[80:95], v[252:255], v[112:115], v[80:95]
    ds_read_b64_tr_b16 v[244:245], v13 offset:4096
    ds_read_b64_tr_b16 v[246:247], v13 offset:5120
    s_waitcnt lgkmcnt(4)
    v_mfma_f32_32x32x16_bf16 v[64:79], v[56:59], v[116:119], v[64:79]
    ds_read_b64_tr_b16 v[248:249], v12 offset:6144
    ds_read_b64_tr_b16 v[250:251], v12 offset:7168
    v_mfma_f32_32x32x16_bf16 v[80:95], v[60:63], v[116:119], v[80:95]
    ds_read_b64_tr_b16 v[252:253], v13 offset:6144
    ds_read_b64_tr_b16 v[254:255], v13 offset:7168
    s_waitcnt lgkmcnt(4)
    v_mfma_f32_32x32x16_bf16 v[64:79], v[240:243], v[120:123], v[64:79]
    v_mfma_f32_32x32x16_bf16 v[80:95], v[244:247], v[120:123], v[80:95]
    s_waitcnt lgkmcnt(0)
    v_mfma_f32_32x32x16_bf16 v[64:79], v[248:251], v[124:127], v[64:79]
    v_mfma_f32_32x32x16_bf16 v[80:95], v[252:255], v[124:127], v[80:95]
    s_nop 10
    ds_write_b128 v0, v[64:67] offset:0
    ds_write_b128 v0, v[68:71] offset:1024
    ds_write_b128 v0, v[72:75] offset:8192
    ds_write_b128 v0, v[76:79] offset:9216
    ds_write_b128 v0, v[80:83] offset:16384
    ds_write_b128 v0, v[84:87] offset:17408
    ds_write_b128 v0, v[88:91] offset:24576
    ds_write_b128 v0, v[92:95] offset:25600
    s_waitcnt lgkmcnt(0)
    s_barrier
    ds_read_b128 v[96:99], v4 offset:0
    ds_read_b128 v[100:103], v4 offset:1024
    ds_read_b128 v[104:107], v4 offset:2048
    ds_read_b128 v[108:111], v4 offset:3072
    ds_read_b128 v[112:115], v4 offset:4096
    ds_read_b128 v[116:119], v4 offset:5120
    ds_read_b128 v[120:123], v4 offset:6144
    ds_read_b128 v[124:127], v4 offset:7168
    s_waitcnt lgkmcnt(5)
    v_add_f32 v96, v96, v104
    v_add_f32 v97, v97, v105
    v_add_f32 v98, v98, v106
    v_add_f32 v99, v99, v107
    s_waitcnt lgkmcnt(4)
    v_add_f32 v100, v100, v108
    v_add_f32 v101, v101, v109
    v_add_f32 v102, v102, v110
    v_add_f32 v103, v103, v111
    s_waitcnt lgkmcnt(1)
    v_add_f32 v112, v112, v120
    v_add_f32 v113, v113, v121
    v_add_f32 v114, v114, v122
    v_add_f32 v115, v115, v123
    s_waitcnt lgkmcnt(0)
    v_add_f32 v116, v116, v124
    v_add_f32 v117, v117, v125
    v_add_f32 v118, v118, v126
    v_add_f32 v119, v119, v127
    v_add_f32 v96, v96, v112
    v_add_f32 v97, v97, v113
    v_add_f32 v98, v98, v114
    v_add_f32 v99, v99, v115
    v_add_f32 v100, v100, v116
    v_add_f32 v101, v101, v117
    v_add_f32 v102, v102, v118
    v_add_f32 v103, v103, v119
    v_permlane32_swap_b32 v20, v22
    v_permlane32_swap_b32 v21, v23
    v_lshlrev_b32 v50, 16, v20
    v_and_b32 v51, 0xffff0000, v20
    v_fma_f32 v50, v96, s75, v50
    v_fma_f32 v51, v97, s75, v51
    v_cvt_pk_bf16_f32 v20, v50, v51
    v_lshlrev_b32 v50, 16, v21
    v_and_b32 v51, 0xffff0000, v21
    v_fma_f32 v50, v98, s75, v50
    v_fma_f32 v51, v99, s75, v51
    v_cvt_pk_bf16_f32 v21, v50, v51
    v_lshlrev_b32 v50, 16, v22
    v_and_b32 v51, 0xffff0000, v22
    v_fma_f32 v50, v100, s75, v50
    v_fma_f32 v51, v101, s75, v51
    v_cvt_pk_bf16_f32 v22, v50, v51
    v_lshlrev_b32 v50, 16, v23
    v_and_b32 v51, 0xffff0000, v23
    v_fma_f32 v50, v102, s75, v50
    v_fma_f32 v51, v103, s75, v51
    v_cvt_pk_bf16_f32 v23, v50, v51
    v_permlane32_swap_b32 v20, v22
    s_nop 0
    v_permlane32_swap_b32 v21, v23
    buffer_store_dwordx4 v[20:23], v18, s[20:23], s7 offen
    s_nop 1
    s_branch L_fin
L_ph2:
    s_barrier
    ds_read_b64_tr_b16 v[56:57], v16 offset:0
    ds_read_b64_tr_b16 v[58:59], v16 offset:1024
    ds_read_b64_tr_b16 v[60:61], v17 offset:0
    ds_read_b64_tr_b16 v[62:63], v17 offset:1024
    ds_read_b64_tr_b16 v[240:241], v16 offset:2048
    ds_read_b64_tr_b16 v[242:243], v16 offset:3072
    ds_read_b64_tr_b16 v[244:245], v17 offset:2048
    ds_read_b64_tr_b16 v[246:247], v17 offset:3072
    s_waitcnt vmcnt(15) lgkmcnt(4)
    v_mfma_f32_32x32x16_bf16 v[64:79], v[56:59], v[128:131], 0
    ds_read_b64_tr_b16 v[248:249], v16 offset:4096
    ds_read_b64_tr_b16 v[250:251], v16 offset:5120
    v_mfma_f32_32x32x16_bf16 v[80:95], v[60:63], v[128:131], 0
    ds_read_b64_tr_b16 v[252:253], v17 offset:4096
    ds_read_b64_tr_b16 v[254:255], v17 offset:5120
    s_lshr_b32 s57, s48, 2
    s_lshl_b32 s57, s57, 15
    s_add_u32 s57, s57, 98304
    s_and_b32 s60, s48, 3
    s_lshl_b32 s59, s60, 11
    s_add_u32 s59, s59, s57
    v_add_u32 v0, s59, v5
    s_lshl_b32 s59, s60, 13
    s_add_u32 s59, s59, s57
    v_add_u32 v4, s59, v5
    s_waitcnt vmcnt(14) lgkmcnt(4)
    v_mfma_f32_32x32x16_bf16 v[64:79], v[240:243], v[132:135], v[64:79]
    ds_read_b64_tr_b16 v[56:57], v16 offset:6144
    ds_read_b64_tr_b16 v[58:59], v16 offset:7168
    v_mfma_f32_32x32x16_bf16 v[80:95], v[244:247], v[132:135], v[80:95]
    ds_read_b64_tr_b16 v[60:61], v17 offset:6144
    ds_read_b64_tr_b16 v[62:63], v17 offset:7168
    s_waitcnt vmcnt(13) lgkmcnt(4)
    v_mfma_f32_32x32x16_bf16 v[64:79], v[248:251], v[136:139], v[64:79]
    ds_read_b64_tr_b16 v[240:241], v14 offset:32768
    ds_read_b64_tr_b16 v[242:243], v14 offset:33792
    v_mfma_f32_32x32x16_bf16 v[80:95], v[252:255], v[136:139], v[80:95]
    ds_read_b64_tr_b16 v[244:245], v15 offset:32768
    ds_read_b64_tr_b16 v[246:247], v15 offset:33792
    s_waitcnt vmcnt(12) lgkmcnt(4)
    v_mfma_f32_32x32x16_bf16 v[64:79], v[56:59], v[140:143], v[64:79]
    ds_read_b64_tr_b16 v[248:249], v14 offset:34816
    ds_read_b64_tr_b16 v[250:251], v14 offset:35840
    v_mfma_f32_32x32x16_bf16 v[80:95], v[60:63], v[140:143], v[80:95]
    ds_read_b64_tr_b16 v[252:253], v15 offset:34816
    ds_read_b64_tr_b16 v[254:255], v15 offset:35840
    s_barrier
    s_add_u32 s58, s3, 172032
    s_add_u32 m0, s76, 131072
    s_waitcnt vmcnt(11) lgkmcnt(4)
    v_mfma_f32_32x32x16_bf16 v[64:79], v[240:243], v[144:147], v[64:79]
    ds_read_b64_tr_b16 v[56:57], v14 offset:36864
    ds_read_b64_tr_b16 v[58:59], v14 offset:37888
    buffer_load_dwordx4 v2, s[24:27], s58 offen offset:0 lds
    buffer_load_dwordx4 v44, s[24:27], s58 offen offset:1024 lds
    v_mfma_f32_32x32x16_bf16 v[80:95], v[244:247], v[144:147], v[80:95]
    ds_read_b64_tr_b16 v[60:61], v15 offset:36864
    ds_read_b64_tr_b16 v[62:63], v15 offset:37888
    buffer_load_dwordx4 v45, s[24:27], s58 offen offset:2048 lds
    buffer_load_dwordx4 v46, s[24:27], s58 offen offset:3072 lds
    s_waitcnt vmcnt(14) lgkmcnt(4)
    v_mfma_f32_32x32x16_bf16 v[64:79], v[248:251], v[148:151], v[64:79]
    ds_read_b64_tr_b16 v[240:241], v14 offset:38912
    ds_read_b64_tr_b16 v[242:243], v14 offset:39936
    buffer_load_dwordx2 v[10:11], v9, s[16:19], s77 offen offset:128 sc1
    v_mfma_f32_32x32x16_bf16 v[80:95], v[252:255], v[148:151], v[80:95]
    ds_read_b64_tr_b16 v[244:245], v15 offset:38912
    ds_read_b64_tr_b16 v[246:247], v15 offset:39936
    s_waitcnt vmcnt(14) lgkmcnt(4)
    v_mfma_f32_32x32x16_bf16 v[64:79], v[56:59], v[152:155], v[64:79]
    ds_read_b64_tr_b16 v[248:249], v14 offset:0
    ds_read_b64_tr_b16 v[250:251], v14 offset:1024
    v_mfma_f32_32x32x16_bf16 v[80:95], v[60:63], v[152:155], v[80:95]
    ds_read_b64_tr_b16 v[252:253], v15 offset:0
    ds_read_b64_tr_b16 v[254:255], v15 offset:1024
    s_waitcnt vmcnt(13) lgkmcnt(4)
    v_mfma_f32_32x32x16_bf16 v[64:79], v[240:243], v[156:159], v[64:79]
    ds_read_b64_tr_b16 v[56:57], v14 offset:2048
    ds_read_b64_tr_b16 v[58:59], v14 offset:3072
    v_mfma_f32_32x32x16_bf16 v[80:95], v[244:247], v[156:159], v[80:95]
    ds_read_b64_tr_b16 v[60:61], v15 offset:2048
    ds_read_b64_tr_b16 v[62:63], v15 offset:3072
    s_barrier
    s_add_u32 s58, s3, 344064
    s_add_u32 m0, s76, 98304
    s_waitcnt vmcnt(12) lgkmcnt(4)
    v_mfma_f32_32x32x16_bf16 v[64:79], v[248:251], v[160:163], v[64:79]
    ds_read_b64_tr_b16 v[240:241], v14 offset:4096
    ds_read_b64_tr_b16 v[242:243], v14 offset:5120
    buffer_load_dwordx4 v2, s[24:27], s58 offen offset:0 lds
    buffer_load_dwordx4 v44, s[24:27], s58 offen offset:1024 lds
    v_mfma_f32_32x32x16_bf16 v[80:95], v[252:255], v[160:163], v[80:95]
    ds_read_b64_tr_b16 v[244:245], v15 offset:4096
    ds_read_b64_tr_b16 v[246:247], v15 offset:5120
    buffer_load_dwordx4 v45, s[24:27], s58 offen offset:2048 lds
    buffer_load_dwordx4 v46, s[24:27], s58 offen offset:3072 lds
    s_waitcnt vmcnt(4)
    v_cmp_ne_u64 s[82:83], v[6:7], v[10:11]
    s_nop 0
    s_cmp_eq_u64 s[82:83], 0
    s_cbranch_scc0 L_ps_33
L_pb_34:
    s_waitcnt lgkmcnt(4)
    v_mfma_f32_32x32x16_bf16 v[64:79], v[56:59], v[164:167], v[64:79]
    ds_read_b64_tr_b16 v[248:249], v14 offset:6144
    ds_read_b64_tr_b16 v[250:251], v14 offset:7168
    v_add_u32 v44, 6144, v3
    v_add_u32 v45, 10496, v2
    v_add_u32 v46, 16640, v3
    s_add_u32 s59, s5, 8192
    buffer_load_dwordx4 v[192:195], v5, s[16:19], s59 offen offset:0 sc1
    v_mfma_f32_32x32x16_bf16 v[80:95], v[60:63], v[164:167], v[80:95]
    ds_read_b64_tr_b16 v[252:253], v15 offset:6144
    ds_read_b64_tr_b16 v[254:255], v15 offset:7168
    buffer_load_dwordx4 v[196:199], v5, s[16:19], s59 offen offset:1024 sc1
    s_waitcnt lgkmcnt(4)
    v_mfma_f32_32x32x16_bf16 v[64:79], v[240:243], v[168:171], v[64:79]
    ds_read_b64_tr_b16 v[56:57], v12 offset:0
    ds_read_b64_tr_b16 v[58:59], v12 offset:1024
    buffer_load_dwordx4 v[200:203], v5, s[16:19], s59 offen offset:2048 sc1
    v_mfma_f32_32x32x16_bf16 v[80:95], v[244:247], v[168:171], v[80:95]
    ds_read_b64_tr_b16 v[60:61], v13 offset:0
    ds_read_b64_tr_b16 v[62:63], v13 offset:1024
    buffer_load_dwordx4 v[204:207], v5, s[16:19], s59 offen offset:3072 sc1
    s_waitcnt lgkmcnt(4)
    v_mfma_f32_32x32x16_bf16 v[64:79], v[248:251], v[172:175], v[64:79]
    ds_read_b64_tr_b16 v[240:241], v12 offset:2048
    ds_read_b64_tr_b16 v[242:243], v12 offset:3072
    s_add_u32 s59, s5, 12288
    buffer_load_dwordx4 v[208:211], v5, s[16:19], s59 offen offset:0 sc1
    v_mfma_f32_32x32x16_bf16 v[80:95], v[252:255], v[172:175], v[80:95]
    ds_read_b64_tr_b16 v[244:245], v13 offset:2048
    ds_read_b64_tr_b16 v[246:247], v13 offset:3072
    s_barrier
    s_add_u32 s58, s4, 0
    s_add_u32 m0, s76, 65536
    buffer_load_dwordx4 v[212:215], v5, s[16:19], s59 offen offset:1024 sc1
    s_waitcnt lgkmcnt(4)
    v_mfma_f32_32x32x16_bf16 v[64:79], v[56:59], v[176:179], v[64:79]
    ds_read_b64_tr_b16 v[248:249], v12 offset:4096
    ds_read_b64_tr_b16 v[250:251], v12 offset:5120
    buffer_load_dwordx4 v2, s[28:31], s58 offen offset:0 lds
    buffer_load_dwordx4 v44, s[28:31], s58 offen offset:1024 lds
    buffer_load_dwordx4 v[216:219], v5, s[16:19], s59 offen offset:2048 sc1
    v_mfma_f32_32x32x16_bf16 v[80:95], v[60:63], v[176:179], v[80:95]
    ds_read_b64_tr_b16 v[252:253], v13 offset:4096
    ds_read_b64_tr_b16 v[254:255], v13 offset:5120
    buffer_load_dwordx4 v45, s[28:31], s58 offen offset:2048 lds
    buffer_load_dwordx4 v46, s[28:31], s58 offen offset:3072 lds
    buffer_load_dwordx4 v[220:223], v5, s[16:19], s59 offen offset:3072 sc1
    s_waitcnt lgkmcnt(4)
    v_mfma_f32_32x32x16_bf16 v[64:79], v[240:243], v[180:183], v[64:79]
    ds_read_b64_tr_b16 v[56:57], v12 offset:6144
    ds_read_b64_tr_b16 v[58:59], v12 offset:7168
    s_add_u32 s59, s5, 24576
    buffer_load_dwordx4 v[224:227], v5, s[16:19], s59 offen offset:0 sc1
    v_mfma_f32_32x32x16_bf16 v[80:95], v[244:247], v[180:183], v[80:95]
    ds_read_b64_tr_b16 v[60:61], v13 offset:6144
    ds_read_b64_tr_b16 v[62:63], v13 offset:7168
    buffer_load_dwordx4 v[228:231], v5, s[16:19], s59 offen offset:1024 sc1
    s_waitcnt lgkmcnt(4)
    v_mfma_f32_32x32x16_bf16 v[64:79], v[248:251], v[184:187], v[64:79]
    ds_read_b64_tr_b16 v[240:241], v12 offset:32768
    ds_read_b64_tr_b16 v[242:243], v12 offset:33792
    buffer_load_dwordx4 v[232:235], v5, s[16:19], s59 offen offset:2048 sc1
    v_mfma_f32_32x32x16_bf16 v[80:95], v[252:255], v[184:187], v[80:95]
    ds_read_b64_tr_b16 v[244:245], v13 offset:32768
    ds_read_b64_tr_b16 v[246:247], v13 offset:33792
    buffer_load_dwordx4 v[236:239], v5, s[16:19], s59 offen offset:3072 sc1
    s_waitcnt lgkmcnt(4)
    v_mfma_f32_32x32x16_bf16 v[64:79], v[56:59], v[188:191], v[64:79]
    ds_read_b64_tr_b16 v[248:249], v12 offset:34816
    ds_read_b64_tr_b16 v[250:251], v12 offset:35840
    v_mfma_f32_32x32x16_bf16 v[80:95], v[60:63], v[188:191], v[80:95]
    ds_read_b64_tr_b16 v[252:253], v13 offset:34816
    ds_read_b64_tr_b16 v[254:255], v13 offset:35840
    s_barrier
    s_add_u32 s58, s4, 50176
    s_add_u32 m0, s76, 0
    s_waitcnt vmcnt(15) lgkmcnt(4)
    v_mfma_f32_32x32x16_bf16 v[64:79], v[240:243], v[192:195], v[64:79]
    ds_read_b64_tr_b16 v[56:57], v12 offset:36864
    ds_read_b64_tr_b16 v[58:59], v12 offset:37888
    buffer_load_dwordx4 v2, s[28:31], s58 offen offset:0 lds
    buffer_load_dwordx4 v44, s[28:31], s58 offen offset:1024 lds
    v_mfma_f32_32x32x16_bf16 v[80:95], v[244:247], v[192:195], v[80:95]
    ds_read_b64_tr_b16 v[60:61], v13 offset:36864
    ds_read_b64_tr_b16 v[62:63], v13 offset:37888
    buffer_load_dwordx4 v45, s[28:31], s58 offen offset:2048 lds
    buffer_load_dwordx4 v46, s[28:31], s58 offen offset:3072 lds
    s_waitcnt vmcnt(18) lgkmcnt(4)
    v_mfma_f32_32x32x16_bf16 v[64:79], v[248:251], v[196:199], v[64:79]
    ds_read_b64_tr_b16 v[240:241], v12 offset:38912
    ds_read_b64_tr_b16 v[242:243], v12 offset:39936
    s_add_u32 s59, s6, 0
    buffer_load_dwordx4 v[96:99], v5, s[16:19], s59 offen offset:0 sc1
    v_mfma_f32_32x32x16_bf16 v[80:95], v[252:255], v[196:199], v[80:95]
    ds_read_b64_tr_b16 v[244:245], v13 offset:38912
    ds_read_b64_tr_b16 v[246:247], v13 offset:39936
    buffer_load_dwordx4 v[100:103], v5, s[16:19], s59 offen offset:1024 sc1
    s_waitcnt vmcnt(19) lgkmcnt(4)
    v_mfma_f32_32x32x16_bf16 v[64:79], v[56:59], v[200:203], v[64:79]
    ds_read_b64_tr_b16 v[248:249], v16 offset:0
    ds_read_b64_tr_b16 v[250:251], v16 offset:1024
    buffer_load_dwordx4 v[104:107], v5, s[16:19], s59 offen offset:2048 sc1
    v_mfma_f32_32x32x16_bf16 v[80:95], v[60:63], v[200:203], v[80:95]
    ds_read_b64_tr_b16 v[252:253], v17 offset:0
    ds_read_b64_tr_b16 v[254:255], v17 offset:1024
    buffer_load_dwordx4 v[108:111], v5, s[16:19], s59 offen offset:3072 sc1
    s_waitcnt vmcnt(20) lgkmcnt(4)
    v_mfma_f32_32x32x16_bf16 v[64:79], v[240:243], v[204:207], v[64:79]
    ds_read_b64_tr_b16 v[56:57], v16 offset:2048
    ds_read_b64_tr_b16 v[58:59], v16 offset:3072
    s_add_u32 s59, s6, 4096
    buffer_load_dwordx4 v[112:115], v5, s[16:19], s59 offen offset:0 sc1
    v_mfma_f32_32x32x16_bf16 v[80:95], v[244:247], v[204:207], v[80:95]
    ds_read_b64_tr_b16 v[60:61], v17 offset:2048
    ds_read_b64_tr_b16 v[62:63], v17 offset:3072
    s_barrier
    buffer_load_dwordx4 v[116:119], v5, s[16:19], s59 offen offset:1024 sc1
    s_waitcnt vmcnt(21) lgkmcnt(4)
    v_mfma_f32_32x32x16_bf16 v[64:79], v[248:251], v[208:211], v[64:79]
    ds_read_b64_tr_b16 v[240:241], v16 offset:4096
    ds_read_b64_tr_b16 v[242:243], v16 offset:5120
    buffer_load_dwordx4 v[120:123], v5, s[16:19], s59 offen offset:2048 sc1
    v_mfma_f32_32x32x16_bf16 v[80:95], v[252:255], v[208:211], v[80:95]
    ds_read_b64_tr_b16 v[244:245], v17 offset:4096
    ds_read_b64_tr_b16 v[246:247], v17 offset:5120
    buffer_load_dwordx4 v[124:127], v5, s[16:19], s59 offen offset:3072 sc1
    s_waitcnt vmcnt(22) lgkmcnt(4)
    v_mfma_f32_32x32x16_bf16 v[64:79], v[56:59], v[212:215], v[64:79]
    ds_read_b64_tr_b16 v[248:249], v16 offset:6144
    ds_read_b64_tr_b16 v[250:251], v16 offset:7168
    v_mfma_f32_32x32x16_bf16 v[80:95], v[60:63], v[212:215], v[80:95]
    ds_read_b64_tr_b16 v[252:253], v17 offset:6144
    ds_read_b64_tr_b16 v[254:255], v17 offset:7168
    s_waitcnt vmcnt(19) lgkmcnt(4)
    v_mfma_f32_32x32x16_bf16 v[64:79], v[240:243], v[216:219], v[64:79]
    ds_read_b64_tr_b16 v[56:57], v14 offset:32768
    ds_read_b64_tr_b16 v[58:59], v14 offset:33792
    v_mfma_f32_32x32x16_bf16 v[80:95], v[244:247], v[216:219], v[80:95]
    ds_read_b64_tr_b16 v[60:61], v15 offset:32768
    ds_read_b64_tr_b16 v[62:63], v15 offset:33792
    s_waitcnt vmcnt(16) lgkmcnt(4)
    v_mfma_f32_32x32x16_bf16 v[64:79], v[248:251], v[220:223], v[64:79]
    ds_read_b64_tr_b16 v[240:241], v14 offset:34816
    ds_read_b64_tr_b16 v[242:243], v14 offset:35840
    v_mfma_f32_32x32x16_bf16 v[80:95], v[252:255], v[220:223], v[80:95]
    ds_read_b64_tr_b16 v[244:245], v15 offset:34816
    ds_read_b64_tr_b16 v[246:247], v15 offset:35840
    s_barrier
    s_waitcnt vmcnt(15) lgkmcnt(4)
    v_mfma_f32_32x32x16_bf16 v[64:79], v[56:59], v[224:227], v[64:79]
    ds_read_b64_tr_b16 v[248:249], v14 offset:36864
    ds_read_b64_tr_b16 v[250:251], v14 offset:37888
    v_mfma_f32_32x32x16_bf16 v[80:95], v[60:63], v[224:227], v[80:95]
    ds_read_b64_tr_b16 v[252:253], v15 offset:36864
    ds_read_b64_tr_b16 v[254:255], v15 offset:37888
    s_waitcnt vmcnt(14) lgkmcnt(4)
    v_mfma_f32_32x32x16_bf16 v[64:79], v[240:243], v[228:231], v[64:79]
    ds_read_b64_tr_b16 v[56:57], v14 offset:38912
    ds_read_b64_tr_b16 v[58:59], v14 offset:39936
    v_mfma_f32_32x32x16_bf16 v[80:95], v[244:247], v[228:231], v[80:95]
    ds_read_b64_tr_b16 v[60:61], v15 offset:38912
    ds_read_b64_tr_b16 v[62:63], v15 offset:39936
    s_waitcnt vmcnt(13) lgkmcnt(4)
    v_mfma_f32_32x32x16_bf16 v[64:79], v[248:251], v[232:235], v[64:79]
    ds_read_b64_tr_b16 v[240:241], v14 offset:0
    ds_read_b64_tr_b16 v[242:243], v14 offset:1024
    v_mfma_f32_32x32x16_bf16 v[80:95], v[252:255], v[232:235], v[80:95]
    ds_read_b64_tr_b16 v[244:245], v15 offset:0
    ds_read_b64_tr_b16 v[246:247], v15 offset:1024
    s_waitcnt vmcnt(7)
    v_xor_b32 v48, v8, v99
    s_waitcnt vmcnt(6)
    v_xor_b32 v49, v8, v103
    v_or_b32 v48, v48, v49
    s_waitcnt vmcnt(5)
    v_xor_b32 v49, v8, v107
    v_or_b32 v48, v48, v49
    s_waitcnt vmcnt(4)
    v_xor_b32 v49, v8, v111
    v_or_b32 v48, v48, v49
    v_cmp_lt_u32 vcc, 0xffff, v48
    s_cbranch_vccnz L_os_36
L_ob_37:
    v_and_b32 v99, 0xffff, v99
    v_and_b32 v103, 0xffff, v103
    v_and_b32 v107, 0xffff, v107
    v_and_b32 v111, 0xffff, v111
    s_waitcnt lgkmcnt(4)
    v_mfma_f32_32x32x16_bf16 v[64:79], v[56:59], v[236:239], v[64:79]
    ds_read_b64_tr_b16 v[248:249], v14 offset:2048
    ds_read_b64_tr_b16 v[250:251], v14 offset:3072
    v_mfma_f32_32x32x16_bf16 v[80:95], v[60:63], v[236:239], v[80:95]
    ds_read_b64_tr_b16 v[252:253], v15 offset:2048
    ds_read_b64_tr_b16 v[254:255], v15 offset:3072
    s_barrier
    s_waitcnt lgkmcnt(4)
    v_mfma_f32_32x32x16_bf16 v[64:79], v[240:243], v[96:99], v[64:79]
    ds_read_b64_tr_b16 v[56:57], v14 offset:4096
    ds_read_b64_tr_b16 v[58:59], v14 offset:5120
    v_mfma_f32_32x32x16_bf16 v[80:95], v[244:247], v[96:99], v[80:95]
    ds_read_b64_tr_b16 v[60:61], v15 offset:4096
    ds_read_b64_tr_b16 v[62:63], v15 offset:5120
    s_waitcnt lgkmcnt(4)
    v_mfma_f32_32x32x16_bf16 v[64:79], v[248:251], v[100:103], v[64:79]
    ds_read_b64_tr_b16 v[240:241], v14 offset:6144
    ds_read_b64_tr_b16 v[242:243], v14 offset:7168
    v_mfma_f32_32x32x16_bf16 v[80:95], v[252:255], v[100:103], v[80:95]
    ds_read_b64_tr_b16 v[244:245], v15 offset:6144
    ds_read_b64_tr_b16 v[246:247], v15 offset:7168
    s_waitcnt lgkmcnt(4)
    v_mfma_f32_32x32x16_bf16 v[64:79], v[56:59], v[104:107], v[64:79]
    ds_read_b64_tr_b16 v[248:249], v12 offset:0
    ds_read_b64_tr_b16 v[250:251], v12 offset:1024
    v_mfma_f32_32x32x16_bf16 v[80:95], v[60:63], v[104:107], v[80:95]
    ds_read_b64_tr_b16 v[252:253], v13 offset:0
    ds_read_b64_tr_b16 v[254:255], v13 offset:1024
    s_waitcnt vmcnt(3)
    v_xor_b32 v48, v8, v115
    s_waitcnt vmcnt(2)
    v_xor_b32 v49, v8, v119
    v_or_b32 v48, v48, v49
    s_waitcnt vmcnt(1)
    v_xor_b32 v49, v8, v123
    v_or_b32 v48, v48, v49
    s_waitcnt vmcnt(0)
    v_xor_b32 v49, v8, v127
    v_or_b32 v48, v48, v49
    v_cmp_lt_u32 vcc, 0xffff, v48
    s_cbranch_vccnz L_os_39
L_ob_40:
    v_and_b32 v115, 0xffff, v115
    v_and_b32 v119, 0xffff, v119
    v_and_b32 v123, 0xffff, v123
    v_and_b32 v127, 0xffff, v127
    s_waitcnt lgkmcnt(4)
    v_mfma_f32_32x32x16_bf16 v[64:79], v[240:243], v[108:111], v[64:79]
    ds_read_b64_tr_b16 v[56:57], v12 offset:2048
    ds_read_b64_tr_b16 v[58:59], v12 offset:3072
    v_mfma_f32_32x32x16_bf16 v[80:95], v[244:247], v[108:111], v[80:95]
    ds_read_b64_tr_b16 v[60:61], v13 offset:2048
    ds_read_b64_tr_b16 v[62:63], v13 offset:3072
    s_waitcnt lgkmcnt(4)
    v_mfma_f32_32x32x16_bf16 v[64:79], v[248:251], v[112:115], v[64:79]
    ds_read_b64_tr_b16 v[240:241], v12 offset:4096
    ds_read_b64_tr_b16 v[242:243], v12 offset:5120
    v_mfma_f32_32x32x16_bf16 v[80:95], v[252:255], v[112:115], v[80:95]
    ds_read_b64_tr_b16 v[244:245], v13 offset:4096
    ds_read_b64_tr_b16 v[246:247], v13 offset:5120
    s_waitcnt lgkmcnt(4)
    v_mfma_f32_32x32x16_bf16 v[64:79], v[56:59], v[116:119], v[64:79]
    ds_read_b64_tr_b16 v[248:249], v12 offset:6144
    ds_read_b64_tr_b16 v[250:251], v12 offset:7168
    v_mfma_f32_32x32x16_bf16 v[80:95], v[60:63], v[116:119], v[80:95]
    ds_read_b64_tr_b16 v[252:253], v13 offset:6144
    ds_read_b64_tr_b16 v[254:255], v13 offset:7168
    s_waitcnt lgkmcnt(4)
    v_mfma_f32_32x32x16_bf16 v[64:79], v[240:243], v[120:123], v[64:79]
    v_mfma_f32_32x32x16_bf16 v[80:95], v[244:247], v[120:123], v[80:95]
    s_waitcnt lgkmcnt(0)
    v_mfma_f32_32x32x16_bf16 v[64:79], v[248:251], v[124:127], v[64:79]
    v_mfma_f32_32x32x16_bf16 v[80:95], v[252:255], v[124:127], v[80:95]
    s_nop 10
    ds_write_b128 v0, v[64:67] offset:0
    ds_write_b128 v0, v[68:71] offset:1024
    ds_write_b128 v0, v[72:75] offset:8192
    ds_write_b128 v0, v[76:79] offset:9216
    ds_write_b128 v0, v[80:83] offset:16384
    ds_write_b128 v0, v[84:87] offset:17408
    ds_write_b128 v0, v[88:91] offset:24576
    ds_write_b128 v0, v[92:95] offset:25600
    s_waitcnt lgkmcnt(0)
    s_barrier
    ds_read_b128 v[96:99], v4 offset:0
    ds_read_b128 v[100:103], v4 offset:1024
    ds_read_b128 v[104:107], v4 offset:2048
    ds_read_b128 v[108:111], v4 offset:3072
    ds_read_b128 v[112:115], v4 offset:4096
    ds_read_b128 v[116:119], v4 offset:5120
    ds_read_b128 v[120:123], v4 offset:6144
    ds_read_b128 v[124:127], v4 offset:7168
    s_waitcnt lgkmcnt(5)
    v_add_f32 v96, v96, v104
    v_add_f32 v97, v97, v105
    v_add_f32 v98, v98, v106
    v_add_f32 v99, v99, v107
    s_waitcnt lgkmcnt(4)
    v_add_f32 v100, v100, v108
    v_add_f32 v101, v101, v109
    v_add_f32 v102, v102, v110
    v_add_f32 v103, v103, v111
    s_waitcnt lgkmcnt(1)
    v_add_f32 v112, v112, v120
    v_add_f32 v113, v113, v121
    v_add_f32 v114, v114, v122
    v_add_f32 v115, v115, v123
    s_waitcnt lgkmcnt(0)
    v_add_f32 v116, v116, v124
    v_add_f32 v117, v117, v125
    v_add_f32 v118, v118, v126
    v_add_f32 v119, v119, v127
    v_add_f32 v96, v96, v112
    v_add_f32 v97, v97, v113
    v_add_f32 v98, v98, v114
    v_add_f32 v99, v99, v115
    v_add_f32 v100, v100, v116
    v_add_f32 v101, v101, v117
    v_add_f32 v102, v102, v118
    v_add_f32 v103, v103, v119
    v_permlane32_swap_b32 v20, v22
    v_permlane32_swap_b32 v21, v23
    v_lshlrev_b32 v50, 16, v20
    v_and_b32 v51, 0xffff0000, v20
    v_fma_f32 v50, v96, s75, v50
    v_fma_f32 v51, v97, s75, v51
    v_cvt_pk_bf16_f32 v20, v50, v51
    v_lshlrev_b32 v50, 16, v21
    v_and_b32 v51, 0xffff0000, v21
    v_fma_f32 v50, v98, s75, v50
    v_fma_f32 v51, v99, s75, v51
    v_cvt_pk_bf16_f32 v21, v50, v51
    v_lshlrev_b32 v50, 16, v22
    v_and_b32 v51, 0xffff0000, v22
    v_fma_f32 v50, v100, s75, v50
    v_fma_f32 v51, v101, s75, v51
    v_cvt_pk_bf16_f32 v22, v50, v51
    v_lshlrev_b32 v50, 16, v23
    v_and_b32 v51, 0xffff0000, v23
    v_fma_f32 v50, v102, s75, v50
    v_fma_f32 v51, v103, s75, v51
    v_cvt_pk_bf16_f32 v23, v50, v51
    v_permlane32_swap_b32 v20, v22
    s_nop 0
    v_permlane32_swap_b32 v21, v23
    buffer_store_dwordx4 v[20:23], v18, s[20:23], s7 offen
L_fin:
    s_waitcnt vmcnt(0) lgkmcnt(0)
L_end:
    s_endpgm
L_ns_1:
    s_mov_b32 s65, 0
    s_nop 1
L_ns_1_l:
    s_sleep 1
    buffer_load_dwordx2 v[6:7], off, s[40:43], 0 sc1
    s_waitcnt vmcnt(0)
    v_readfirstlane_b32 s66, v6
    s_add_u32 s65, s65, 1
    s_cmp_lg_u32 s66, 0
    s_nop 2
    s_cbranch_scc1 L_nb_2
    s_cmp_lt_u32 s65, 20000
    s_nop 1
    s_cbranch_scc1 L_ns_1_l
    s_branch L_nb_2
L_ss_3:
    s_mov_b32 s65, 0
    s_nop 1
L_ss_3_l:
    s_sleep 1
    buffer_load_dwordx4 v[44:47], v11, s[16:19], s45 offen sc1
    s_waitcnt vmcnt(0)
    v_cmp_ne_u32 s[82:83], v6, v47
    s_add_u32 s65, s65, 1
    s_cmp_eq_u64 s[82:83], 0
    s_nop 2
    s_cbranch_scc1 L_sb_4
    s_cmp_lt_u32 s65, 20000
    s_nop 1
    s_cbranch_scc1 L_ss_3_l
    s_branch L_sb_4
L_ps_5:
    s_mov_b32 s65, 0
    s_nop 1
L_pq_7:
    s_sleep 1
    buffer_load_dwordx2 v[10:11], v9, s[16:19], s77 offen offset:0 sc1
    s_waitcnt vmcnt(0)
    v_cmp_ne_u64 s[82:83], v[6:7], v[10:11]
    s_add_u32 s65, s65, 1
    s_cmp_eq_u64 s[82:83], 0
    s_nop 2
    s_cbranch_scc1 L_pb_6
    s_cmp_lt_u32 s65, 20000
    s_nop 1
    s_cbranch_scc1 L_pq_7
    s_branch L_pb_6
L_ss_8:
    s_mov_b32 s65, 0
    s_nop 1
L_ss_8_l:
    s_sleep 1
    buffer_load_dwordx4 v[44:47], v11, s[16:19], s45 offen sc1
    s_waitcnt vmcnt(0)
    v_cmp_ne_u32 s[82:83], v6, v47
    s_add_u32 s65, s65, 1
    s_cmp_eq_u64 s[82:83], 0
    s_nop 2
    s_cbranch_scc1 L_sb_9
    s_cmp_lt_u32 s65, 20000
    s_nop 1
    s_cbranch_scc1 L_ss_8_l
    s_branch L_sb_9
L_ps_10:
    s_mov_b32 s65, 0
    s_nop 1
L_pq_12:
    s_sleep 1
    buffer_load_dwordx2 v[10:11], v9, s[16:19], s77 offen offset:0 sc1
    s_waitcnt vmcnt(0)
    v_cmp_ne_u64 s[82:83], v[6:7], v[10:11]
    s_add_u32 s65, s65, 1
    s_cmp_eq_u64 s[82:83], 0
    s_nop 2
    s_cbranch_scc1 L_pb_11
    s_cmp_lt_u32 s65, 20000
    s_nop 1
    s_cbranch_scc1 L_pq_12
    s_branch L_pb_11
L_ns_14:
    s_mov_b32 s65, 0
    s_nop 1
L_ns_14_l:
    s_sleep 1
    buffer_load_dwordx2 v[6:7], off, s[40:43], 0 sc1
    s_waitcnt vmcnt(0)
    v_readfirstlane_b32 s66, v6
    s_add_u32 s65, s65, 1
    s_cmp_lg_u32 s66, 0
    s_nop 2
    s_cbranch_scc1 L_nb_15
    s_cmp_lt_u32 s65, 20000
    s_nop 1
    s_cbranch_scc1 L_ns_14_l
    s_branch L_nb_15
L_ss_16:
    s_mov_b32 s65, 0
    s_nop 1
L_ss_16_l:
    s_sleep 1
    v_and_b32 v48, 31, v1
    v_lshlrev_b32 v48, 4, v48
    s_lshl_b32 s82, s71, 4
    s_add_u32 s82, s82, 11534336
    buffer_load_dwordx4 v[44:47], v48, s[16:19], s82 offen sc1
    s_waitcnt vmcnt(0)
    v_cmp_ne_u32 s[82:83], v6, v47
    s_add_u32 s65, s65, 1
    s_cmp_eq_u64 s[82:83], 0
    s_nop 2
    s_cbranch_scc1 L_sb_17
    s_cmp_lt_u32 s65, 20000
    s_nop 1
    s_cbranch_scc1 L_ss_16_l
    s_branch L_sb_17
L_ps_18:
    s_mov_b32 s65, 0
    s_nop 1
L_pq_20:
    s_sleep 1
    buffer_load_dwordx2 v[10:11], v9, s[16:19], s77 offen offset:0 sc1
    s_waitcnt vmcnt(0)
    v_cmp_ne_u64 s[82:83], v[6:7], v[10:11]
    s_add_u32 s65, s65, 1
    s_cmp_eq_u64 s[82:83], 0
    s_nop 2
    s_cbranch_scc1 L_pb_19
    s_cmp_lt_u32 s65, 20000
    s_nop 1
    s_cbranch_scc1 L_pq_20
    s_branch L_pb_19
L_gs_21:
    s_mov_b32 s65, 0
    s_nop 1
L_gq_23:
    s_sleep 1
    s_add_u32 s82, s74, 0
    buffer_load_dwordx4 v[224:227], v16, s[16:19], s82 offen sc1
    s_add_u32 s82, s74, 8192
    buffer_load_dwordx4 v[228:231], v16, s[16:19], s82 offen sc1
    s_add_u32 s82, s74, 16384
    buffer_load_dwordx4 v[232:235], v16, s[16:19], s82 offen sc1
    s_add_u32 s82, s74, 24576
    buffer_load_dwordx4 v[236:239], v16, s[16:19], s82 offen sc1
    s_waitcnt vmcnt(0)
    v_xor_b32 v53, v8, v227
    v_xor_b32 v54, v8, v231
    v_or_b32 v53, v53, v54
    v_xor_b32 v54, v8, v235
    v_or_b32 v53, v53, v54
    v_xor_b32 v54, v8, v239
    v_or_b32 v53, v53, v54
    v_cmp_lt_u32 vcc, 0xffff, v53
    s_add_u32 s65, s65, 1
    s_nop 3
    s_cbranch_vccz L_gb_22
    s_cmp_lt_u32 s65, 20000
    s_nop 1
    s_cbranch_scc1 L_gq_23
    s_branch L_gb_22
L_ps_24:
    s_waitcnt vmcnt(0)
    v_cmp_ne_u64 s[82:83], v[6:7], v[10:11]
    s_mov_b32 s65, 0
    s_cmp_eq_u64 s[82:83], 0
    s_nop 2
    s_cbranch_scc1 L_pb_25
L_pq_26:
    s_sleep 1
    buffer_load_dwordx2 v[10:11], v9, s[16:19], s77 offen offset:128 sc1
    s_waitcnt vmcnt(0)
    v_cmp_ne_u64 s[82:83], v[6:7], v[10:11]
    s_add_u32 s65, s65, 1
    s_cmp_eq_u64 s[82:83], 0
    s_nop 2
    s_cbranch_scc1 L_pb_25
    s_cmp_lt_u32 s65, 20000
    s_nop 1
    s_cbranch_scc1 L_pq_26
    s_branch L_pb_25
L_os_27:
    s_mov_b32 s65, 0
    s_nop 1
L_oq_29:
    s_sleep 1
    s_add_u32 s82, s6, 0
    buffer_load_dwordx4 v[96:99], v5, s[16:19], s82 offen sc1
    s_add_u32 s82, s6, 1024
    buffer_load_dwordx4 v[100:103], v5, s[16:19], s82 offen sc1
    s_add_u32 s82, s6, 2048
    buffer_load_dwordx4 v[104:107], v5, s[16:19], s82 offen sc1
    s_add_u32 s82, s6, 3072
    buffer_load_dwordx4 v[108:111], v5, s[16:19], s82 offen sc1
    s_waitcnt vmcnt(0)
    v_xor_b32 v48, v8, v99
    v_xor_b32 v49, v8, v103
    v_or_b32 v48, v48, v49
    v_xor_b32 v49, v8, v107
    v_or_b32 v48, v48, v49
    v_xor_b32 v49, v8, v111
    v_or_b32 v48, v48, v49
    v_cmp_lt_u32 vcc, 0xffff, v48
    s_add_u32 s65, s65, 1
    s_nop 3
    s_cbranch_vccz L_ob_28
    s_cmp_lt_u32 s65, 20000
    s_nop 1
    s_cbranch_scc1 L_oq_29
    s_branch L_ob_28
L_os_30:
    s_mov_b32 s65, 0
    s_nop 1
L_oq_32:
    s_sleep 1
    s_add_u32 s82, s6, 4096
    buffer_load_dwordx4 v[112:115], v5, s[16:19], s82 offen sc1
    s_add_u32 s82, s6, 5120
    buffer_load_dwordx4 v[116:119], v5, s[16:19], s82 offen sc1
    s_add_u32 s82, s6, 6144
    buffer_load_dwordx4 v[120:123], v5, s[16:19], s82 offen sc1
    s_add_u32 s82, s6, 7168
    buffer_load_dwordx4 v[124:127], v5, s[16:19], s82 offen sc1
    s_waitcnt vmcnt(0)
    v_xor_b32 v48, v8, v115
    v_xor_b32 v49, v8, v119
    v_or_b32 v48, v48, v49
    v_xor_b32 v49, v8, v123
    v_or_b32 v48, v48, v49
    v_xor_b32 v49, v8, v127
    v_or_b32 v48, v48, v49
    v_cmp_lt_u32 vcc, 0xffff, v48
    s_add_u32 s65, s65, 1
    s_nop 3
    s_cbranch_vccz L_ob_31
    s_cmp_lt_u32 s65, 20000
    s_nop 1
    s_cbranch_scc1 L_oq_32
    s_branch L_ob_31
L_ps_33:
    s_mov_b32 s65, 0
    s_nop 1
L_pq_35:
    s_sleep 1
    buffer_load_dwordx2 v[10:11], v9, s[16:19], s77 offen offset:128 sc1
    s_waitcnt vmcnt(0)
    v_cmp_ne_u64 s[82:83], v[6:7], v[10:11]
    s_add_u32 s65, s65, 1
    s_cmp_eq_u64 s[82:83], 0
    s_nop 2
    s_cbranch_scc1 L_pb_34
    s_cmp_lt_u32 s65, 20000
    s_nop 1
    s_cbranch_scc1 L_pq_35
    s_branch L_pb_34
L_os_36:
    s_mov_b32 s65, 0
    s_nop 1
L_oq_38:
    s_sleep 1
    s_add_u32 s82, s6, 0
    buffer_load_dwordx4 v[96:99], v5, s[16:19], s82 offen sc1
    s_add_u32 s82, s6, 1024
    buffer_load_dwordx4 v[100:103], v5, s[16:19], s82 offen sc1
    s_add_u32 s82, s6, 2048
    buffer_load_dwordx4 v[104:107], v5, s[16:19], s82 offen sc1
    s_add_u32 s82, s6, 3072
    buffer_load_dwordx4 v[108:111], v5, s[16:19], s82 offen sc1
    s_waitcnt vmcnt(0)
    v_xor_b32 v48, v8, v99
    v_xor_b32 v49, v8, v103
    v_or_b32 v48, v48, v49
    v_xor_b32 v49, v8, v107
    v_or_b32 v48, v48, v49
    v_xor_b32 v49, v8, v111
    v_or_b32 v48, v48, v49
    v_cmp_lt_u32 vcc, 0xffff, v48
    s_add_u32 s65, s65, 1
    s_nop 3
    s_cbranch_vccz L_ob_37
    s_cmp_lt_u32 s65, 20000
    s_nop 1
    s_cbranch_scc1 L_oq_38
    s_branch L_ob_37
L_os_39:
    s_mov_b32 s65, 0
    s_nop 1
L_oq_41:
    s_sleep 1
    s_add_u32 s82, s6, 4096
    buffer_load_dwordx4 v[112:115], v5, s[16:19], s82 offen sc1
    s_add_u32 s82, s6, 5120
    buffer_load_dwordx4 v[116:119], v5, s[16:19], s82 offen sc1
    s_add_u32 s82, s6, 6144
    buffer_load_dwordx4 v[120:123], v5, s[16:19], s82 offen sc1
    s_add_u32 s82, s6, 7168
    buffer_load_dwordx4 v[124:127], v5, s[16:19], s82 offen sc1
    s_waitcnt vmcnt(0)
    v_xor_b32 v48, v8, v115
    v_xor_b32 v49, v8, v119
    v_or_b32 v48, v48, v49
    v_xor_b32 v49, v8, v123
    v_or_b32 v48, v48, v49
    v_xor_b32 v49, v8, v127
    v_or_b32 v48, v48, v49
    v_cmp_lt_u32 vcc, 0xffff, v48
    s_add_u32 s65, s65, 1
    s_nop 3
    s_cbranch_vccz L_ob_40
    s_cmp_lt_u32 s65, 20000
    s_nop 1
    s_cbranch_scc1 L_oq_41
    s_branch L_ob_40
.section .rodata,"a"
.p2align 6
.amdhsa_kernel parallel_sum__linear_kernel_hedgehog__dense_activation_mish__prompt_kernel
  .amdhsa_next_free_vgpr 256
  .amdhsa_next_free_sgpr 102
  .amdhsa_accum_offset 256
  .amdhsa_group_segment_fixed_size 0
  .amdhsa_kernarg_size 88
  .amdhsa_user_sgpr_count 2
  .amdhsa_user_sgpr_kernarg_segment_ptr 1
  .amdhsa_system_sgpr_workgroup_id_x 1
.end_amdhsa_kernel
```
